```python
import torch

def _softmax(x, axis=-1):
    return torch.softmax(x, dim=axis)
def _gelu(x):
    return torch.nn.functional.gelu(x, approximate="tanh")
def _silu(x):
    return torch.nn.functional.silu(x)
def _sigmoid(x):
    return torch.sigmoid(x)
def _layernorm(x, axis=-1, eps=1e-5):
    m = x.mean(dim=axis, keepdim=True)
    v = x.var(dim=axis, keepdim=True, unbiased=False)
    return (x - m) / torch.sqrt(v + eps)
def _scatter_add(tgt, idx, src, axis=0):
    return tgt.clone().index_add_(axis, idx, src)
def _segment_sum(src, seg, n):
    out = torch.zeros((n,) + src.shape[1:], dtype=src.dtype)
    return out.index_add_(0, seg, src)
def _pad(x, pw):
    flat = tuple(v for pair in reversed(pw) for v in pair)
    return torch.nn.functional.pad(x, flat)

kernel_name = 'recurrent_scan__ssm_conv_h3__dense_activation_gelu__prompt'

def setup_inputs():

    _w = (lambda a: (lambda t: t.to(torch.bfloat16) if t.is_floating_point() else t)(torch.as_tensor(a)))
    def _A_setup():
        B, S, D = 1, 2048, 512
        ks = 4
        return {
            "q": _w((lambda *s: torch.randn(*s, dtype=torch.bfloat16) * 0.05)(B, S, D)),
            "k": _w((lambda *s: torch.randn(*s, dtype=torch.bfloat16) * 0.8)(B, S, D)),
            "v": _w((lambda *s: torch.randn(*s, dtype=torch.bfloat16) * 0.8)(B, S, D)),
            "shift_k": _w((lambda *s: torch.randn(*s, dtype=torch.bfloat16) * 0.8)(D, ks) * 0.5),
            "ssm_k": _w((lambda *s: torch.randn(*s, dtype=torch.bfloat16) * 0.8)(D, S) * (1.0 / S ** 0.5)),
            "ssm_D": _w((lambda *s: torch.randn(*s, dtype=torch.bfloat16) * 0.8)(D)),
        }
    _A_in = _A_setup()

    def _B_setup():
        B, S, D, F = 1, 2048, 512, 1792
        return {
            "x": _w((lambda *s: torch.randn(*s, dtype=torch.bfloat16) * 0.05)(B, S, D)),
            "w1": _w((lambda *s: torch.randn(*s, dtype=torch.bfloat16) * 0.2)(D, F) * (D ** -0.5)),
            "b1": _w((lambda *s: torch.randn(*s, dtype=torch.bfloat16) * 0.2)(F) * 0.01),
            "w2": _w((lambda *s: torch.randn(*s, dtype=torch.bfloat16) * 0.2)(F, D) * (F ** -0.5)),
            "b2": _w((lambda *s: torch.randn(*s, dtype=torch.bfloat16) * 0.2)(D) * 0.01),
        }
    _B_in = _B_setup()

    return {
        "A_q": _A_in["q"],
        "A_k": _A_in["k"],
        "A_v": _A_in["v"],
        "A_shift_k": _A_in["shift_k"],
        "A_ssm_k": _A_in["ssm_k"],
        "A_ssm_D": _A_in["ssm_D"],
        "B_x": _B_in["x"],
        "B_w1": _B_in["w1"],
        "B_b1": _B_in["b1"],
        "B_w2": _B_in["w2"],
        "B_b2": _B_in["b2"],
    }

def reference(A_q, A_k, A_v, A_shift_k, A_ssm_k, A_ssm_D, B_x, B_w1, B_b1, B_w2, B_b2):
    def _A_ref(q, k, v, shift_k, ssm_k, ssm_D):
        B, S, D = q.shape
        ks = shift_k.shape[-1]
        k_pad = _pad(k, ((0, 0), (ks - 1, 0), (0, 0)))
        k_shift = torch.zeros_like(k)
        for t in range(ks):
            k_shift = k_shift + k_pad[:, t:t + S, :] * shift_k[:, ks - 1 - t][None, None, :]
        kv = k_shift * v
        L = 2 * S
        kv_pad = _pad(kv, ((0, 0), (0, S), (0, 0)))
        kf_pad = _pad(ssm_k, ((0, 0), (0, S)))
        kv_f = (lambda x, axes=(-2,-1): torch.fft.rfft2(x.float(), dim=axes))(kv_pad[:, None, :, :], axes=(1, 2))
        kf_f = (lambda x, axes=(-2,-1): torch.fft.rfft2(x.float(), dim=axes))(kf_pad[:, None, :], axes=(1, 2))
        kf_f = (lambda x, *d: x.permute(*d))(kf_f, 1, 2, 0)
        y_f = kv_f * kf_f[None, :, :, :]
        y = (lambda x, s, axes=(-2,-1): torch.fft.irfft2(x, s=s, dim=axes).to(torch.bfloat16))(y_f, (1, L), axes=(1, 2))[:, 0, :S, :]
        y = y + kv * ssm_D[None, None, :]
        return q * y

    def _B_ref(x, w1, b1, w2, b2):
        h = torch.einsum("bsd,df->bsf", x, w1) + b1
        h = _gelu(h)
        return torch.einsum("bsf,fd->bsd", h, w2) + b2

    x = A_q
    xn = _layernorm(x, axis=-1)
    s = _A_ref(xn, A_k, A_v, A_shift_k, A_ssm_k, A_ssm_D)
    g = _silu(_B_ref(xn, B_w1, B_b1, B_w2, B_b2))
    return x + s * g
```

```asm
; @launch grid=(256,1,1) block=(512,1,1) lds=162176
.amdgcn_target "amdgcn-amd-amdhsa--gfx950"
.text
.globl recurrent_scan__ssm_conv_h3__dense_activation_gelu__prompt_kernel
.p2align 12
.p2align 8
.type recurrent_scan__ssm_conv_h3__dense_activation_gelu__prompt_kernel,@function
recurrent_scan__ssm_conv_h3__dense_activation_gelu__prompt_kernel:
s_load_dwordx2 s[48:49], s[0:1], 0
s_load_dwordx2 s[60:61], s[0:1], 56
v_lshrrev_b32 v1, 6, v0
v_and_b32 v0, 63, v0
v_readfirstlane_b32 s41, v1
s_cmp_ge_u32 s2, 256
s_cbranch_scc1 L_end
s_cmp_ge_u32 s41, 4
s_cbranch_scc1 L_X
s_load_dwordx2 s[64:65], s[0:1], 104
s_getpc_b64 s[44:45]
L_pc:
s_lshr_b32 s46, s2, 3
s_lshl2_add_u32 s46, s46, s41
s_lshl_b32 s46, s46, 8
v_lshl_add_u32 v2, v0, 7, s46
v_min_u32 v2, L_code_end-L_pc-4, v2
v_mov_b32 v3, s45
v_add_co_u32 v2, vcc, s44, v2
s_mov_b64 exec, 3
s_nop 0
v_addc_co_u32 v3, vcc, 0, v3, vcc
global_load_dword v254, v[2:3], off
s_mov_b64 exec, -1
s_and_b32 s33, s2, 7
s_lshr_b32 s34, s2, 3
s_lshr_b32 s44, s33, 1
s_and_b32 s45, s33, 1
s_and_b32 s46, s34, 3
s_lshr_b32 s42, s34, 2
s_lshl2_add_u32 s35, s44, s46
s_lshl3_add_u32 s40, s45, s42
s_lshl_b32 s37, s44, 1
s_mov_b32 s50, 2097152
s_mov_b32 s51, 0x20000
s_and_b32 s32, s41, 3
v_lshlrev_b32 v1, 4, v0
v_lshrrev_b32 v10, 3, v0
v_lshrrev_b32 v11, 4, v0
v_and_b32 v12, 7, v0
s_lshl_b32 s88, s35, 7
s_lshl3_add_u32 s88, s40, s88
s_lshl1_add_u32 s88, s32, s88
s_lshl_b32 s89, s88, 10
s_or_b32 s90, s34, s32
s_mov_b32 s66, 12582912
s_mov_b32 s67, s51
v_mov_b32 v248, 0
v_mov_b32 v249, 0
v_mov_b32 v250, 0
v_mov_b32 v251, 0
s_waitcnt lgkmcnt(0)
s_cmp_lg_u32 s90, 0
s_cbranch_scc1 Lnolead_1001
v_min_u32 v13, 47, v0
v_lshlrev_b32 v13, 8, v13
s_mul_i32 s44, s2, 12288
s_lshl_b32 s45, s2, 11
s_add_u32 s45, s45, 131072
buffer_store_dwordx4 v[248:251], v1, s[64:67], s45 offen sc1
buffer_store_dwordx4 v[248:251], v1, s[64:67], s45 offen offset:1024 sc1
buffer_store_dword v248, v13, s[64:67], s44 offen sc1
Lnolead_1001:
buffer_load_dwordx4 v[96:99], v1, s[48:51], s89 offen
buffer_load_dwordx4 v[100:103], v1, s[48:51], s89 offen offset:1024
s_and_b32 s98, s32, 1
s_lshr_b32 s99, s32, 1
s_load_dwordx16 s[4:19], s[0:1], 0
s_load_dwordx8 s[20:27], s[0:1], 64
s_load_dwordx4 s[28:31], s[0:1], 96
v_and_b32 v13, 16, v1
v_add_u32 v13, 160128, v13
ds_write_b128 v13, v[248:251]
v_and_b32 v12, 15, v0
v_lshrrev_b32 v13, 1, v12
v_xor_b32 v13, v13, v11
v_lshlrev_b32 v13, 4, v13
v_lshl_add_u32 v13, v12, 7, v13
s_lshl_b32 s44, s98, 6
v_xor_b32 v13, s44, v13
s_lshl_b32 s44, s98, 13
v_add_u32 v2, s44, v13
v_xor_b32 v3, 64, v2
v_lshlrev_b32 v8, 3, v12
v_bfe_u32 v12, v0, 2, 3
v_bfe_u32 v13, v0, 2, 2
v_lshl_add_u32 v13, v11, 3, v13
v_lshlrev_b32 v13, 8, v13
v_and_b32 v10, 3, v0
v_lshl_add_u32 v13, v10, 3, v13
v_add_u32 v13, 49152, v13
s_lshl_b32 s45, s99, 2
v_xor_b32 v10, s45, v12
s_add_u32 s45, s45, 1
v_lshl_add_u32 v4, v10, 5, v13
v_xor_b32 v10, s45, v12
s_add_u32 s45, s45, 1
v_lshl_add_u32 v5, v10, 5, v13
v_xor_b32 v10, s45, v12
s_add_u32 s45, s45, 1
v_lshl_add_u32 v6, v10, 5, v13
v_xor_b32 v10, s45, v12
s_add_u32 s45, s45, 1
v_lshl_add_u32 v7, v10, 5, v13
s_lshl_b32 s44, s98, 13
s_xor_b32 s45, s44, 8192
v_add_u32 v204, s45, v4
v_add_u32 v4, s44, v4
v_add_u32 v205, s45, v5
v_add_u32 v5, s44, v5
v_add_u32 v206, s45, v6
v_add_u32 v6, s44, v6
v_add_u32 v207, s45, v7
v_add_u32 v7, s44, v7
s_cmp_lg_u32 s90, 0
s_cbranch_scc1 Lnolead_1002
s_waitcnt vmcnt(2) lgkmcnt(0)
s_lshl_b32 s44, s2, 2
s_mov_b32 s3, 1
s_atomic_add s3, s[28:29], s44
Lnolead_1002:
s_branch L_M2
L_X:
s_and_b32 s33, s2, 7
s_lshr_b32 s34, s2, 3
s_lshr_b32 s44, s33, 1
s_and_b32 s45, s33, 1
s_and_b32 s46, s34, 3
s_lshr_b32 s42, s34, 2
s_lshl2_add_u32 s35, s44, s46
s_lshl3_add_u32 s40, s45, s42
s_lshl_b32 s37, s44, 1
s_mov_b32 s50, 2097152
s_mov_b32 s51, 0x20000
s_and_b32 s32, s41, 3
v_lshlrev_b32 v1, 4, v0
v_lshrrev_b32 v10, 3, v0
v_lshrrev_b32 v11, 4, v0
v_and_b32 v12, 7, v0
v_xor_b32 v13, v12, v11
v_lshlrev_b32 v13, 4, v13
v_lshl_add_u32 v14, v10, 10, v13
s_lshl2_add_u32 s44, s35, s32
s_lshl_b32 s44, s44, 15
s_movk_i32 s46, 7168
s_lshl_b32 s47, s46, 1
v_add_u32 v14, s44, v14
v_xor_b32 v15, 64, v14
v_add_u32 v16, s47, v14
v_add_u32 v15, s46, v15
v_add_u32 v17, s47, v15
s_lshl_b32 s89, s32, 12
s_lshl_b32 s91, s37, 7
s_mov_b32 m0, s89
s_and_b32 s45, s33, 1
s_sub_u32 s36, s40, s45
s_min_u32 s36, s36, 13
s_cmp_eq_u32 s42, 7
s_cbranch_scc1 L_Xs
s_waitcnt lgkmcnt(0)
buffer_load_dwordx4 v14, s[48:51], s91 offen  lds
buffer_load_dwordx4 v15, s[48:51], s91 offen offset:1024  lds
buffer_load_dwordx4 v16, s[48:51], s91 offen offset:2048  lds
buffer_load_dwordx4 v17, s[48:51], s91 offen offset:3072  lds
v_lshlrev_b32 v13, 5, v11
v_xor_b32 v13, v13, v1
v_and_b32 v13, 0xff, v13
v_xor_b32 v20, 0x80, v13
s_lshl_b32 s46, s36, 8
s_mul_i32 s45, s32, 57344
s_add_u32 s44, s46, s45
s_movk_i32 s45, 3584
s_movk_i32 s46, 13312
s_lshl1_add_u32 s47, s46, s44
v_mad_u32_u24 v18, v11, s45, v13
v_mad_u32_u24 v20, v11, s45, v20
v_add_u32 v18, s44, v18
v_add_u32 v20, s47, v20
v_add_u32 v19, s46, v18
v_add_u32 v21, s46, v20
s_mov_b32 s62, 1835008
s_mov_b32 s63, s51
s_mul_i32 s92, s37, 229376
s_add_u32 m0, s89, 49152
s_nop 0
buffer_load_dwordx4 v18, s[60:63], s92 offen  lds
buffer_load_dwordx4 v19, s[60:63], s92 offen offset:1024  lds
buffer_load_dwordx4 v20, s[60:63], s92 offen offset:2048  lds
buffer_load_dwordx4 v21, s[60:63], s92 offen offset:3072  lds
s_add_u32 s44, s37, 1
s_and_b32 s44, s44, 7
s_lshl_b32 s91, s44, 7
s_mul_i32 s92, s44, 229376
s_add_u32 m0, s89, 16384
s_nop 0
buffer_load_dwordx4 v14, s[48:51], s91 offen  lds
buffer_load_dwordx4 v15, s[48:51], s91 offen offset:1024  lds
buffer_load_dwordx4 v16, s[48:51], s91 offen offset:2048  lds
L_Xs:
s_load_dwordx16 s[4:19], s[0:1], 0
s_load_dwordx8 s[20:27], s[0:1], 64
s_load_dwordx4 s[28:31], s[0:1], 96
s_and_b32 s45, s33, 1
s_and_b32 s46, s34, 3
s_lshl_b32 s43, s32, 11
s_lshl1_add_u32 s47, s46, s42
s_and_b32 s38, s42, 1
s_lshr_b32 s39, s42, 1
s_xor_b32 s47, s38, 1
s_cmp_lt_u32 s42, 6
s_cselect_b32 s47, s45, s47
s_cselect_b32 s38, s38, s45
s_lshl2_add_u32 s39, s47, s39
s_lshl1_add_u32 s38, s35, s38
s_waitcnt lgkmcnt(0)
v_mov_b32 v11, v12
s_mov_b64 s[64:65], s[30:31]
s_mov_b32 s66, 12582912
s_mov_b32 s67, 0x20000
s_mov_b64 s[68:69], s[28:29]
s_mov_b32 s70, 256
s_mov_b32 s71, 0x20000
s_mov_b64 s[72:73], s[22:23]
s_mov_b32 s74, 1835008
s_mov_b32 s75, 0x20000
s_mov_b64 s[76:77], s[12:13]
s_mov_b32 s78, 2097152
s_mov_b32 s79, 0x20000
s_lshl_b32 s44, s33, 6
s_lshl1_add_u32 s44, s34, s44
s_lshr_b32 s45, s32, 1
s_add_u32 s93, s44, s45
s_mul_i32 s45, s45, 17600
s_and_b32 s46, s32, 1
s_lshl_b32 s47, s46, 11
s_add_u32 s17, s45, s47
s_add_u32 s17, s17, 120064
s_mul_i32 s47, s46, 4224
s_add_u32 s47, s47, s45
s_add_u32 s47, s47, 115328
s_mul_i32 s44, s46, 4576
s_add_u32 s44, s44, s45
s_add_u32 s44, s44, 128256
v_mov_b32 v12, s44
v_mov_b32 v13, s47
v_cmp_gt_u32 vcc, 56, v0
v_mov_b32 v112, 0
v_mov_b32 v113, 0
v_mov_b32 v114, 0
v_mov_b32 v115, 0
v_cndmask_b32 v13, v13, v12, vcc
v_lshl_add_u32 v13, v0, 3, v13
v_subrev_u32 v12, 4, v12
ds_write_b64 v13, v[112:113]
ds_write_b32 v12, v112
v_lshlrev_b32 v30, 2, v11
v_and_b32 v12, 6, v10
v_xor_b32 v12, v12, v11
v_lshlrev_b32 v12, 4, v12
v_lshl_add_u32 v2, v10, 10, v12
s_mul_i32 s44, s32, 458752
s_lshl_b32 s45, s39, 7
s_add_u32 s44, s44, s45
v_add_u32 v2, s44, v2
v_add_u32 v3, 7168, v2
v_lshrrev_b32 v13, 2, v0
v_lshlrev_b32 v13, 7, v13
v_and_b32 v12, 3, v10
v_lshl_add_u32 v13, v12, 5, v13
v_and_b32 v12, 3, v0
v_lshl_add_u32 v13, v12, 3, v13
v_add_u32 v4, s43, v13
v_xor_b32 v5, 32, v4
v_xor_b32 v6, 64, v4
v_xor_b32 v7, 0x60, v4
v_add_u32 v138, 65536, v4
v_add_u32 v139, 65536, v5
v_add_u32 v140, 65536, v6
v_add_u32 v141, 65536, v7
s_mul_i32 s44, s38, 229376
s_mul_i32 s45, s32, 28672
s_add_u32 s44, s44, s45
s_add_u32 s44, s44, 5242880
v_add_u32 v8, s44, v1
s_lshr_b32 s44, s34, 3
s_lshl2_add_u32 s44, s33, s44
s_lshl2_add_u32 s44, s44, s32
s_lshl_b32 s95, s44, 8
s_lshl_b32 s44, s93, 12
s_and_b32 s45, s32, 1
s_lshl_b32 s45, s45, 11
s_add_u32 s90, s44, s45
v_xor_b32 v13, 7, v11
v_lshlrev_b32 v13, 4, v13
v_lshl_add_u32 v29, v10, 13, v13
s_lshl2_add_u32 s46, s33, s32
s_lshr_b32 s45, s34, 3
s_lshl2_add_u32 s44, s46, s45
s_lshl_b32 s98, s44, 8
s_lshl_b32 s46, s46, 16
s_lshl_b32 s47, s34, 7
s_sub_u32 s46, s46, s47
s_add_u32 s0, s46, 1052544
s_add_u32 s1, s0, 4096
s_mov_b64 s[52:53], s[6:7]
s_mov_b32 s54, 2097152
s_mov_b32 s55, 0x20000
s_mov_b64 s[56:57], s[8:9]
s_mov_b32 s58, 2097152
s_mov_b32 s59, 0x20000
s_lshl_b32 s44, s32, 1
v_xor_b32 v13, s44, v11
v_lshlrev_b32 v13, 4, v13
v_lshl_add_u32 v22, v10, 10, v13
v_xor_b32 v23, 16, v22
v_add_u32 v23, 7168, v23
s_lshl2_add_u32 s88, s34, s32
s_lshl_b32 s88, s88, 7
s_add_u32 s88, s88, s33
s_lshl_b32 s88, s88, 7
v_lshrrev_b32 v28, 5, v0
v_add_u32 v28, s44, v28
v_bfe_u32 v12, v0, 3, 2
v_lshlrev_b32 v12, 2, v12
v_lshl_add_u32 v12, v11, 10, v12
v_add_u32 v13, 7, v11
v_and_b32 v13, 7, v13
v_xor_b32 v13, v28, v13
v_lshl_add_u32 v27, v13, 4, v12
v_add_u32 v27, 98304, v27
v_xor_b32 v13, v28, v11
v_lshl_add_u32 v26, v13, 4, v12
v_add_u32 v28, 107520, v26
v_add_u32 v26, 99328, v26
s_lshl_b32 s44, s32, 7
s_add_u32 s44, s44, 160192
v_lshl_add_u32 v25, v10, 4, s44
v_add_u32 v116, 161088, v1
v_mov_b32 v117, 0xffff0000
s_lshl_b32 s99, s35, 10
s_add_u32 s99, s99, 131072
s_waitcnt lgkmcnt(0)
s_cmp_eq_u32 s42, 7
s_cbranch_scc1 L_Xh
buffer_load_dwordx4 v17, s[48:51], s91 offen offset:3072  lds
s_add_u32 m0, s89, 65536
s_nop 0
buffer_load_dwordx4 v18, s[60:63], s92 offen  lds
buffer_load_dwordx4 v19, s[60:63], s92 offen offset:1024  lds
buffer_load_dwordx4 v20, s[60:63], s92 offen offset:2048  lds
buffer_load_dwordx4 v21, s[60:63], s92 offen offset:3072  lds
s_setprio 1
s_waitcnt vmcnt(8)
s_barrier
s_mov_b64 exec, 15
ds_read_b128 v[120:123], v116
s_mov_b64 exec, -1
s_add_u32 m0, s43, 99328
s_nop 0
buffer_load_dwordx4 v22, s[52:55], s88 offen nt lds
buffer_load_dwordx4 v23, s[52:55], s88 offen offset:1024 nt lds
s_cmp_eq_u32 s32, 3
s_cbranch_scc1 Lhalo_8
s_lshl_b32 s44, s33, 9
s_lshl_b32 s45, s36, 8
s_cmp_eq_u32 s32, 0
s_cselect_b64 s[46:47], s[10:11], s[20:21]
s_cselect_b32 s44, s44, s45
s_lshl_b32 s45, s39, 7
s_cmp_eq_u32 s32, 2
s_cselect_b64 s[46:47], s[24:25], s[46:47]
s_cselect_b32 s44, s45, s44
v_add_u32 v24, s44, v1
s_lshr_b32 s44, 32, s32
s_lshl_b32 s45, s44, 5
s_sub_u32 m0, 161216, s45
s_bfm_b64 exec, s44, 0
global_load_lds_dwordx4 v24, s[46:47]
s_branch Lsmd_9
Lhalo_8:
s_sub_u32 s44, s88, 57344
s_cselect_b32 s44, 0, s44
s_cselect_b32 s45, 0x80000010, 16
v_xor_b32 v24, s45, v22
s_mov_b32 m0, 98304
s_lshl_b64 exec, -1, 40
buffer_load_dwordx4 v24, s[52:55], s44 offen nt lds
Lsmd_9:
s_add_u32 m0, s43, 107520
s_mov_b64 exec, -1
buffer_load_dwordx4 v22, s[56:59], s88 offen nt lds
buffer_load_dwordx4 v23, s[56:59], s88 offen offset:1024 nt lds
s_mov_b32 m0, s17
s_lshl_b32 s44, s93, 12
buffer_load_dwordx4 v1, s[76:79], s90 offen nt lds
buffer_load_dwordx4 v1, s[76:79], s90 offen offset:1024 nt lds
s_add_u32 s44, s44, 2044
s_load_dword s88, s[12:13], s44
s_add_u32 s44, s37, 2
s_and_b32 s44, s44, 7
s_lshl_b32 s91, s44, 7
s_mul_i32 s92, s44, 229376
s_add_u32 m0, s89, 32768
s_nop 0
buffer_load_dwordx4 v14, s[48:51], s91 offen  lds
s_waitcnt vmcnt(15)
buffer_load_dwordx4 v15, s[48:51], s91 offen offset:1024  lds
s_waitcnt vmcnt(15)
buffer_load_dwordx4 v16, s[48:51], s91 offen offset:2048  lds
s_waitcnt vmcnt(15)
buffer_load_dwordx4 v17, s[48:51], s91 offen offset:3072  lds
s_waitcnt vmcnt(11)
s_barrier
s_add_u32 m0, s89, 81920
s_nop 0
buffer_load_dwordx4 v18, s[60:63], s92 offen  lds
buffer_load_dwordx4 v19, s[60:63], s92 offen offset:1024  lds
buffer_load_dwordx4 v20, s[60:63], s92 offen offset:2048  lds
buffer_load_dwordx4 v21, s[60:63], s92 offen offset:3072  lds
s_add_u32 s44, s37, 3
s_and_b32 s44, s44, 7
s_lshl_b32 s91, s44, 7
s_mul_i32 s92, s44, 229376
s_add_u32 m0, s89, 0
s_nop 0
buffer_load_dwordx4 v14, s[48:51], s91 offen  lds
s_waitcnt lgkmcnt(0)
s_cmp_lg_u32 s32, 0
s_cbranch_scc1 Lmk_10
s_load_dwordx8 s[80:87], s[28:29], 0
Lmk_10:
s_waitcnt vmcnt(15)
buffer_load_dwordx4 v15, s[48:51], s91 offen offset:1024  lds
s_waitcnt vmcnt(15)
buffer_load_dwordx4 v16, s[48:51], s91 offen offset:2048  lds
s_waitcnt vmcnt(15)
buffer_load_dwordx4 v17, s[48:51], s91 offen offset:3072  lds
s_add_u32 m0, s89, 49152
s_nop 0
s_waitcnt vmcnt(15)
buffer_load_dwordx4 v18, s[60:63], s92 offen  lds
s_waitcnt vmcnt(15)
buffer_load_dwordx4 v19, s[60:63], s92 offen offset:1024  lds
s_waitcnt vmcnt(15)
buffer_load_dwordx4 v20, s[60:63], s92 offen offset:2048  lds
s_waitcnt vmcnt(15)
buffer_load_dwordx4 v21, s[60:63], s92 offen offset:3072  lds
s_cmp_lg_u32 s32, 0
s_cbranch_scc1 Lmk_11
s_waitcnt lgkmcnt(0)
s_and_b64 s[80:81], s[80:81], s[82:83]
s_and_b64 s[84:85], s[84:85], s[86:87]
s_and_b64 s[80:81], s[80:81], s[84:85]
s_and_b32 s80, s80, s81
s_cbranch_scc1 Lmk_11
s_mov_b32 s94, 0
Lpoll_12:
buffer_load_dword v31, v30, s[68:71], 0 offen sc1
s_waitcnt vmcnt(0)
v_cmp_ne_u32 vcc, 1, v31
s_add_u32 s94, s94, 1
s_cmp_gt_u32 s94, 131072
s_cbranch_scc1 Lpolld_13
s_cbranch_vccnz Lpoll_12
Lpolld_13:
Lmk_11:
s_waitcnt vmcnt(8)
s_barrier
s_cmp_lg_u32 s32, 0
s_cbranch_scc1 Lpb_14
s_lshl_b32 s44, s40, 6
s_add_u32 s44, s44, s99
s_mov_b64 exec, 15
buffer_store_dwordx4 v[120:123], v1, s[64:67], s44 offen sc1
s_mov_b64 exec, -1
Lpb_14:
s_add_u32 s44, s37, 4
s_and_b32 s44, s44, 7
s_lshl_b32 s91, s44, 7
s_mul_i32 s92, s44, 229376
s_add_u32 m0, s89, 16384
s_nop 0
buffer_load_dwordx4 v14, s[48:51], s91 offen  lds
ds_read_b128 v[108:111], v25
ds_read_b32 v33, v27 offset:640
ds_read2_b32 v[34:35], v27 offset0:192 offset1:224
ds_read2_b32 v[36:37], v26 offset0:0 offset1:32
ds_read2_b32 v[38:39], v26 offset0:64 offset1:96
ds_read2_b32 v[40:41], v26 offset0:128 offset1:160
ds_read2_b32 v[42:43], v26 offset0:192 offset1:224
ds_read2_b32 v[44:45], v28 offset0:0 offset1:32
ds_read2_b32 v[46:47], v28 offset0:64 offset1:96
ds_read2_b32 v[48:49], v28 offset0:128 offset1:160
buffer_load_dwordx4 v15, s[48:51], s91 offen offset:1024  lds
ds_read2_b32 v[50:51], v28 offset0:192 offset1:224
s_waitcnt lgkmcnt(0)
v_lshlrev_b32 v80, 16, v108
v_and_b32 v81, v117, v108
v_lshlrev_b32 v82, 16, v109
v_and_b32 v83, v117, v109
v_lshlrev_b32 v84, 16, v110
v_and_b32 v85, v117, v110
v_lshlrev_b32 v86, 16, v111
v_and_b32 v87, v117, v111
buffer_load_dwordx4 v16, s[48:51], s91 offen offset:2048  lds
v_lshlrev_b32 v57, 16, v33
v_lshlrev_b32 v58, 16, v34
v_lshlrev_b32 v59, 16, v35
v_lshlrev_b32 v60, 16, v36
v_lshlrev_b32 v61, 16, v37
v_lshlrev_b32 v62, 16, v38
v_lshlrev_b32 v63, 16, v39
v_lshlrev_b32 v64, 16, v40
v_lshlrev_b32 v65, 16, v41
v_lshlrev_b32 v66, 16, v42
buffer_load_dwordx4 v17, s[48:51], s91 offen offset:3072  lds
v_lshlrev_b32 v67, 16, v43
v_mul_f32 v100, v57, v83
v_mul_f32 v101, v58, v83
v_mul_f32 v102, v59, v83
v_mul_f32 v103, v60, v83
v_mul_f32 v104, v61, v83
v_mul_f32 v105, v62, v83
v_mul_f32 v106, v63, v83
v_mul_f32 v107, v64, v83
v_fmac_f32 v100, v58, v82
s_add_u32 m0, s89, 65536
s_nop 0
buffer_load_dwordx4 v18, s[60:63], s92 offen  lds
v_fmac_f32 v101, v59, v82
v_fmac_f32 v102, v60, v82
v_fmac_f32 v103, v61, v82
v_fmac_f32 v104, v62, v82
v_fmac_f32 v105, v63, v82
v_fmac_f32 v106, v64, v82
v_fmac_f32 v107, v65, v82
v_fmac_f32 v100, v59, v81
v_fmac_f32 v101, v60, v81
v_fmac_f32 v102, v61, v81
buffer_load_dwordx4 v19, s[60:63], s92 offen offset:1024  lds
v_fmac_f32 v103, v62, v81
v_fmac_f32 v104, v63, v81
v_fmac_f32 v105, v64, v81
v_fmac_f32 v106, v65, v81
v_fmac_f32 v107, v66, v81
v_fmac_f32 v100, v60, v80
v_fmac_f32 v101, v61, v80
v_fmac_f32 v102, v62, v80
v_fmac_f32 v103, v63, v80
v_fmac_f32 v104, v64, v80
buffer_load_dwordx4 v20, s[60:63], s92 offen offset:2048  lds
v_fmac_f32 v105, v65, v80
v_fmac_f32 v106, v66, v80
v_fmac_f32 v107, v67, v80
v_lshlrev_b32 v88, 16, v44
v_mul_f32 v100, v100, v88
v_lshlrev_b32 v89, 16, v45
v_mul_f32 v101, v101, v89
v_lshlrev_b32 v88, 16, v46
v_mul_f32 v102, v102, v88
v_lshlrev_b32 v89, 16, v47
buffer_load_dwordx4 v21, s[60:63], s92 offen offset:3072  lds
v_mul_f32 v103, v103, v89
v_lshlrev_b32 v88, 16, v48
v_mul_f32 v104, v104, v88
v_lshlrev_b32 v89, 16, v49
v_mul_f32 v105, v105, v89
v_lshlrev_b32 v88, 16, v50
v_mul_f32 v106, v106, v88
v_lshlrev_b32 v89, 16, v51
v_mul_f32 v107, v107, v89
v_cvt_pk_bf16_f32 v92, v107, v106
s_waitcnt vmcnt(8)
s_barrier
s_add_u32 s44, s37, 5
s_and_b32 s44, s44, 7
s_lshl_b32 s91, s44, 7
s_mul_i32 s92, s44, 229376
s_add_u32 m0, s89, 32768
s_nop 0
buffer_load_dwordx4 v14, s[48:51], s91 offen  lds
v_cvt_pk_bf16_f32 v93, v105, v104
v_cvt_pk_bf16_f32 v94, v103, v102
v_cvt_pk_bf16_f32 v95, v101, v100
buffer_store_dwordx4 v[92:95], v29, s[64:67], s0 offen sc1
v_and_b32 v57, v117, v33
v_and_b32 v58, v117, v34
v_and_b32 v59, v117, v35
v_and_b32 v60, v117, v36
v_and_b32 v61, v117, v37
buffer_load_dwordx4 v15, s[48:51], s91 offen offset:1024  lds
v_and_b32 v62, v117, v38
v_and_b32 v63, v117, v39
v_and_b32 v64, v117, v40
v_and_b32 v65, v117, v41
v_and_b32 v66, v117, v42
v_and_b32 v67, v117, v43
v_mul_f32 v100, v57, v87
v_mul_f32 v101, v58, v87
v_mul_f32 v102, v59, v87
buffer_load_dwordx4 v16, s[48:51], s91 offen offset:2048  lds
v_mul_f32 v103, v60, v87
v_mul_f32 v104, v61, v87
v_mul_f32 v105, v62, v87
v_mul_f32 v106, v63, v87
v_mul_f32 v107, v64, v87
v_fmac_f32 v100, v58, v86
v_fmac_f32 v101, v59, v86
v_fmac_f32 v102, v60, v86
v_fmac_f32 v103, v61, v86
buffer_load_dwordx4 v17, s[48:51], s91 offen offset:3072  lds
v_fmac_f32 v104, v62, v86
v_fmac_f32 v105, v63, v86
v_fmac_f32 v106, v64, v86
v_fmac_f32 v107, v65, v86
v_fmac_f32 v100, v59, v85
v_fmac_f32 v101, v60, v85
v_fmac_f32 v102, v61, v85
v_fmac_f32 v103, v62, v85
v_fmac_f32 v104, v63, v85
s_add_u32 m0, s89, 81920
s_nop 0
buffer_load_dwordx4 v18, s[60:63], s92 offen  lds
v_fmac_f32 v105, v64, v85
v_fmac_f32 v106, v65, v85
v_fmac_f32 v107, v66, v85
v_fmac_f32 v100, v60, v84
v_fmac_f32 v101, v61, v84
v_fmac_f32 v102, v62, v84
v_fmac_f32 v103, v63, v84
v_fmac_f32 v104, v64, v84
v_fmac_f32 v105, v65, v84
buffer_load_dwordx4 v19, s[60:63], s92 offen offset:1024  lds
v_fmac_f32 v106, v66, v84
v_fmac_f32 v107, v67, v84
v_and_b32 v88, v117, v44
v_mul_f32 v100, v100, v88
v_and_b32 v89, v117, v45
v_mul_f32 v101, v101, v89
v_and_b32 v88, v117, v46
v_mul_f32 v102, v102, v88
v_and_b32 v89, v117, v47
buffer_load_dwordx4 v20, s[60:63], s92 offen offset:2048  lds
v_mul_f32 v103, v103, v89
v_and_b32 v88, v117, v48
v_mul_f32 v104, v104, v88
v_and_b32 v89, v117, v49
v_mul_f32 v105, v105, v89
v_and_b32 v88, v117, v50
v_mul_f32 v106, v106, v88
v_and_b32 v89, v117, v51
v_mul_f32 v107, v107, v89
s_waitcnt vmcnt(15)
buffer_load_dwordx4 v21, s[60:63], s92 offen offset:3072  lds
v_cvt_pk_bf16_f32 v96, v107, v106
v_cvt_pk_bf16_f32 v97, v105, v104
v_cvt_pk_bf16_f32 v98, v103, v102
v_cvt_pk_bf16_f32 v99, v101, v100
s_waitcnt vmcnt(15)
buffer_store_dwordx4 v[96:99], v29, s[64:67], s1 offen sc1
s_waitcnt vmcnt(10)
s_barrier
s_add_u32 s44, s37, 6
s_and_b32 s44, s44, 7
s_lshl_b32 s91, s44, 7
s_mul_i32 s92, s44, 229376
s_add_u32 m0, s89, 0
s_nop 0
buffer_load_dwordx4 v14, s[48:51], s91 offen  lds
buffer_load_dwordx4 v15, s[48:51], s91 offen offset:1024  lds
buffer_load_dwordx4 v16, s[48:51], s91 offen offset:2048  lds
buffer_load_dwordx4 v17, s[48:51], s91 offen offset:3072  lds
s_add_u32 m0, s89, 49152
s_nop 0
buffer_load_dwordx4 v18, s[60:63], s92 offen  lds
buffer_load_dwordx4 v19, s[60:63], s92 offen offset:1024  lds
s_waitcnt vmcnt(15)
buffer_load_dwordx4 v20, s[60:63], s92 offen offset:2048  lds
s_waitcnt vmcnt(15)
buffer_load_dwordx4 v21, s[60:63], s92 offen offset:3072  lds
s_waitcnt vmcnt(9)
s_barrier
s_waitcnt vmcnt(8)
s_movk_i32 s3, 1
s_atomic_add s3, s[30:31], s98
s_add_u32 s44, s37, 7
s_and_b32 s44, s44, 7
s_lshl_b32 s91, s44, 7
s_mul_i32 s92, s44, 229376
s_add_u32 m0, s89, 16384
s_nop 0
buffer_load_dwordx4 v14, s[48:51], s91 offen  lds
buffer_load_dwordx4 v15, s[48:51], s91 offen offset:1024  lds
buffer_load_dwordx4 v16, s[48:51], s91 offen offset:2048  lds
buffer_load_dwordx4 v17, s[48:51], s91 offen offset:3072  lds
s_add_u32 m0, s89, 65536
s_nop 0
buffer_load_dwordx4 v18, s[60:63], s92 offen  lds
buffer_load_dwordx4 v19, s[60:63], s92 offen offset:1024  lds
buffer_load_dwordx4 v20, s[60:63], s92 offen offset:2048  lds
buffer_load_dwordx4 v21, s[60:63], s92 offen offset:3072  lds
s_waitcnt vmcnt(8)
s_barrier
s_cmp_lg_u32 s32, 1
s_cbranch_scc1 Lsd_15
s_mov_b32 m0, 161152
s_nop 0
buffer_load_dwordx4 v1, s[64:67], s99 offen sc1 lds
Lsd_15:
s_add_u32 m0, s43, 98304
s_mov_b32 s44, 393216
buffer_load_dwordx4 v2, s[72:75], s44 offen  lds
buffer_load_dwordx4 v3, s[72:75], s44 offen offset:1024  lds
s_add_u32 m0, s43, 106496
s_mov_b32 s44, 409600
buffer_load_dwordx4 v2, s[72:75], s44 offen  lds
buffer_load_dwordx4 v3, s[72:75], s44 offen offset:1024  lds
s_add_u32 m0, s43, 32768
s_mov_b32 s44, 131072
buffer_load_dwordx4 v2, s[72:75], s44 offen  lds
buffer_load_dwordx4 v3, s[72:75], s44 offen offset:1024  lds
s_add_u32 m0, s43, 40960
s_mov_b32 s44, 147456
buffer_load_dwordx4 v2, s[72:75], s44 offen  lds
buffer_load_dwordx4 v3, s[72:75], s44 offen offset:1024  lds
s_waitcnt vmcnt(8)
s_barrier
s_setprio 0
L_Xj:
s_load_dword s16, s[30:31], s95 glc
s_add_u32 m0, s43, 81920
s_mov_b32 s44, 327680
s_waitcnt vmcnt(8)
buffer_load_dwordx4 v2, s[72:75], s44 offen  lds
s_waitcnt vmcnt(8)
buffer_load_dwordx4 v3, s[72:75], s44 offen offset:1024  lds
s_add_u32 m0, s43, 90112
s_mov_b32 s44, 344064
s_waitcnt vmcnt(8)
buffer_load_dwordx4 v2, s[72:75], s44 offen  lds
s_waitcnt vmcnt(8)
buffer_load_dwordx4 v3, s[72:75], s44 offen offset:1024  lds
s_waitcnt lgkmcnt(0)
s_cmp_eq_u32 s16, 8
s_cbranch_scc1 Lurok_16
s_mov_b32 s94, 0
Lsp_17:
s_load_dword s16, s[30:31], s95 glc
s_add_u32 s94, s94, 1
s_waitcnt lgkmcnt(0)
s_cmp_eq_u32 s16, 8
s_cbranch_scc1 Lspd_18
s_cmp_gt_u32 s94, 131072
s_cbranch_scc0 Lsp_17
Lspd_18:
Lurok_16:
s_cmp_lg_u32 s42, 7
s_cbranch_scc1 Lhs_19
s_cmp_lg_u32 s32, 1
s_cbranch_scc1 Lsd_20
s_mov_b32 m0, 161152
s_nop 0
buffer_load_dwordx4 v1, s[64:67], s99 offen sc1 lds
Lsd_20:
Lhs_19:
s_xor_b32 s45, s32, 3
s_lshl_b32 s45, s45, 10
s_and_b32 s44, s93, 0xfffffffe
s_lshl_b32 s44, s44, 12
s_add_u32 s44, s44, s45
s_add_u32 s44, s44, 1048576
s_add_u32 m0, s45, 124160
s_nop 0
s_waitcnt vmcnt(8)
buffer_load_dwordx4 v1, s[64:67], s44 offen sc1 lds
s_add_u32 m0, s45, 141760
s_add_u32 s44, s44, 4096
s_waitcnt vmcnt(8)
buffer_load_dwordx4 v1, s[64:67], s44 offen sc1 lds
s_add_u32 s45, s45, 124160
v_add_u32 v60, s45, v1
v_add_u32 v61, 4572, v60
v_add_u32 v62, 17600, v61
s_add_u32 m0, s43, 0
s_mov_b32 s44, 0
s_waitcnt vmcnt(8)
buffer_load_dwordx4 v2, s[72:75], s44 offen  lds
s_waitcnt vmcnt(8)
buffer_load_dwordx4 v3, s[72:75], s44 offen offset:1024  lds
s_add_u32 m0, s43, 8192
s_mov_b32 s44, 16384
s_waitcnt vmcnt(8)
buffer_load_dwordx4 v2, s[72:75], s44 offen  lds
s_waitcnt vmcnt(8)
buffer_load_dwordx4 v3, s[72:75], s44 offen offset:1024  lds
s_add_u32 m0, s43, 49152
s_mov_b32 s44, 196608
s_waitcnt vmcnt(8)
buffer_load_dwordx4 v2, s[72:75], s44 offen  lds
s_waitcnt vmcnt(8)
buffer_load_dwordx4 v3, s[72:75], s44 offen offset:1024  lds
s_add_u32 m0, s43, 57344
s_mov_b32 s44, 212992
s_waitcnt vmcnt(8)
buffer_load_dwordx4 v2, s[72:75], s44 offen  lds
s_waitcnt vmcnt(8)
buffer_load_dwordx4 v3, s[72:75], s44 offen offset:1024  lds
v_mov_b32 v10, 160128
s_mov_b32 s94, 0
Lsy_21:
ds_read_b32 v11, v10 offset:16
s_add_u32 s94, s94, 1
s_waitcnt lgkmcnt(0)
v_cmp_ne_u32 vcc, 4, v11
s_cmp_gt_u32 s94, 1048576
s_cbranch_scc1 Lsyd_22
s_cbranch_vccnz Lsy_21
Lsyd_22:
s_setprio 1
s_lshl2_add_u32 s44, s38, s32
s_add_u32 s44, s44, 128
s_lshl_b32 s98, s44, 8
s_add_u32 m0, s43, 16384
s_mov_b32 s44, 65536
s_waitcnt vmcnt(8)
buffer_load_dwordx4 v2, s[72:75], s44 offen  lds
s_waitcnt vmcnt(8)
buffer_load_dwordx4 v3, s[72:75], s44 offen offset:1024  lds
v_add_u32 v10, s17, v1
v_subrev_u32 v11, 4, v10
v_subrev_u32 v12, 4224, v10
s_bitcmp1_b32 s32, 0
s_cselect_b32 s88, s88, 0
ds_read_b128 v[40:43], v10 offset:0
ds_read_b32 v44, v11 offset:0
ds_read_b128 v[48:51], v10 offset:1024
ds_read_b32 v52, v11 offset:1024
ds_read_b128 v[64:67], v60 offset:0
ds_read_b128 v[68:71], v60 offset:17600
s_add_u32 m0, s43, 24576
s_mov_b32 s44, 81920
s_waitcnt vmcnt(8)
buffer_load_dwordx4 v2, s[72:75], s44 offen  lds
s_waitcnt vmcnt(8)
buffer_load_dwordx4 v3, s[72:75], s44 offen offset:1024  lds
s_waitcnt lgkmcnt(2)
v_writelane_b32 v44, s88, 0
v_alignbit_b32 v43, v43, v42, 16
v_alignbit_b32 v42, v42, v41, 16
v_alignbit_b32 v41, v41, v40, 16
v_alignbit_b32 v40, v40, v44, 16
ds_write_b128 v12, v[40:43] offset:0
v_alignbit_b32 v51, v51, v50, 16
v_alignbit_b32 v50, v50, v49, 16
v_alignbit_b32 v49, v49, v48, 16
v_alignbit_b32 v48, v48, v52, 16
ds_write_b128 v12, v[48:51] offset:1024
s_waitcnt lgkmcnt(2)
ds_write2_b32 v61, v64, v65 offset0:0 offset1:1
ds_write2_b32 v61, v66, v67 offset0:2 offset1:3
ds_write2_b32 v62, v68, v69 offset0:0 offset1:1
ds_write2_b32 v62, v70, v71 offset0:2 offset1:3
v_mov_b32 v10, 160128
v_mov_b32 v11, 1
s_mov_b64 exec, 1
ds_add_u32 v10, v11 offset:0
s_mov_b64 exec, -1
s_add_u32 m0, s43, 65536
s_mov_b32 s44, 262144
s_waitcnt vmcnt(8)
buffer_load_dwordx4 v2, s[72:75], s44 offen  lds
s_waitcnt vmcnt(8)
buffer_load_dwordx4 v3, s[72:75], s44 offen offset:1024  lds
ds_read_b64_tr_b16 v[238:239], v138 offset:32768
ds_read_b64_tr_b16 v[242:243], v139 offset:32768
ds_read_b64_tr_b16 v[246:247], v140 offset:32768
ds_read_b64_tr_b16 v[250:251], v141 offset:32768
ds_read_b64_tr_b16 v[240:241], v138 offset:40960
ds_read_b64_tr_b16 v[244:245], v139 offset:40960
ds_read_b64_tr_b16 v[248:249], v140 offset:40960
s_waitcnt lgkmcnt(13)
ds_read_b64_tr_b16 v[252:253], v141 offset:40960
s_add_u32 m0, s43, 73728
s_mov_b32 s44, 278528
s_waitcnt vmcnt(8)
buffer_load_dwordx4 v2, s[72:75], s44 offen  lds
s_waitcnt vmcnt(8)
buffer_load_dwordx4 v3, s[72:75], s44 offen offset:1024  lds
s_waitcnt lgkmcnt(13)
ds_read_b64_tr_b16 v[174:175], v4 offset:32768
s_waitcnt lgkmcnt(13)
ds_read_b64_tr_b16 v[178:179], v5 offset:32768
s_waitcnt lgkmcnt(13)
ds_read_b64_tr_b16 v[182:183], v6 offset:32768
s_waitcnt lgkmcnt(13)
ds_read_b64_tr_b16 v[186:187], v7 offset:32768
s_waitcnt lgkmcnt(13)
ds_read_b64_tr_b16 v[176:177], v4 offset:40960
s_waitcnt lgkmcnt(13)
ds_read_b64_tr_b16 v[180:181], v5 offset:40960
s_waitcnt lgkmcnt(13)
ds_read_b64_tr_b16 v[184:185], v6 offset:40960
s_waitcnt lgkmcnt(13)
ds_read_b64_tr_b16 v[188:189], v7 offset:40960
s_waitcnt lgkmcnt(13)
ds_read_b64_tr_b16 v[222:223], v138 offset:16384
s_waitcnt lgkmcnt(13)
ds_read_b64_tr_b16 v[226:227], v139 offset:16384
s_waitcnt lgkmcnt(13)
ds_read_b64_tr_b16 v[230:231], v140 offset:16384
s_waitcnt lgkmcnt(13)
ds_read_b64_tr_b16 v[234:235], v141 offset:16384
s_waitcnt lgkmcnt(13)
ds_read_b64_tr_b16 v[224:225], v138 offset:24576
s_waitcnt lgkmcnt(13)
ds_read_b64_tr_b16 v[228:229], v139 offset:24576
s_waitcnt lgkmcnt(13)
ds_read_b64_tr_b16 v[232:233], v140 offset:24576
s_waitcnt lgkmcnt(13)
ds_read_b64_tr_b16 v[236:237], v141 offset:24576
s_add_u32 m0, s43, 98304
s_mov_b32 s44, 425984
s_waitcnt vmcnt(8)
buffer_load_dwordx4 v2, s[72:75], s44 offen  lds
s_waitcnt vmcnt(8)
buffer_load_dwordx4 v3, s[72:75], s44 offen offset:1024  lds
s_waitcnt lgkmcnt(13)
ds_read_b64_tr_b16 v[142:143], v4 offset:0
s_waitcnt lgkmcnt(13)
ds_read_b64_tr_b16 v[146:147], v5 offset:0
s_waitcnt lgkmcnt(13)
ds_read_b64_tr_b16 v[150:151], v6 offset:0
s_waitcnt lgkmcnt(13)
ds_read_b64_tr_b16 v[154:155], v7 offset:0
s_waitcnt lgkmcnt(13)
ds_read_b64_tr_b16 v[144:145], v4 offset:8192
s_waitcnt lgkmcnt(13)
ds_read_b64_tr_b16 v[148:149], v5 offset:8192
s_waitcnt lgkmcnt(13)
ds_read_b64_tr_b16 v[152:153], v6 offset:8192
s_waitcnt lgkmcnt(13)
ds_read_b64_tr_b16 v[156:157], v7 offset:8192
s_waitcnt lgkmcnt(13)
ds_read_b64_tr_b16 v[190:191], v4 offset:49152
s_waitcnt lgkmcnt(13)
ds_read_b64_tr_b16 v[194:195], v5 offset:49152
s_waitcnt lgkmcnt(13)
ds_read_b64_tr_b16 v[198:199], v6 offset:49152
s_waitcnt lgkmcnt(13)
ds_read_b64_tr_b16 v[202:203], v7 offset:49152
s_waitcnt lgkmcnt(13)
ds_read_b64_tr_b16 v[192:193], v4 offset:57344
s_waitcnt lgkmcnt(13)
ds_read_b64_tr_b16 v[196:197], v5 offset:57344
s_waitcnt lgkmcnt(13)
ds_read_b64_tr_b16 v[200:201], v6 offset:57344
s_waitcnt lgkmcnt(13)
ds_read_b64_tr_b16 v[204:205], v7 offset:57344
s_add_u32 m0, s43, 106496
s_mov_b32 s44, 442368
s_waitcnt vmcnt(8)
buffer_load_dwordx4 v2, s[72:75], s44 offen  lds
s_waitcnt vmcnt(8)
buffer_load_dwordx4 v3, s[72:75], s44 offen offset:1024  lds
s_waitcnt lgkmcnt(13)
ds_read_b64_tr_b16 v[158:159], v4 offset:16384
s_waitcnt lgkmcnt(13)
ds_read_b64_tr_b16 v[162:163], v5 offset:16384
s_waitcnt lgkmcnt(13)
ds_read_b64_tr_b16 v[166:167], v6 offset:16384
s_waitcnt lgkmcnt(13)
ds_read_b64_tr_b16 v[170:171], v7 offset:16384
s_add_u32 m0, s43, 32768
s_mov_b32 s44, 163840
s_waitcnt vmcnt(8)
buffer_load_dwordx4 v2, s[72:75], s44 offen  lds
s_waitcnt vmcnt(8)
buffer_load_dwordx4 v3, s[72:75], s44 offen offset:1024  lds
s_waitcnt lgkmcnt(13)
ds_read_b64_tr_b16 v[160:161], v4 offset:24576
s_waitcnt lgkmcnt(13)
ds_read_b64_tr_b16 v[164:165], v5 offset:24576
s_waitcnt lgkmcnt(13)
ds_read_b64_tr_b16 v[168:169], v6 offset:24576
s_waitcnt lgkmcnt(13)
ds_read_b64_tr_b16 v[172:173], v7 offset:24576
s_add_u32 m0, s43, 40960
s_mov_b32 s44, 180224
s_waitcnt vmcnt(8)
buffer_load_dwordx4 v2, s[72:75], s44 offen  lds
s_waitcnt vmcnt(8)
buffer_load_dwordx4 v3, s[72:75], s44 offen offset:1024  lds
s_waitcnt lgkmcnt(13)
ds_read_b64_tr_b16 v[206:207], v138 offset:0
s_waitcnt lgkmcnt(13)
ds_read_b64_tr_b16 v[210:211], v139 offset:0
s_waitcnt lgkmcnt(13)
ds_read_b64_tr_b16 v[214:215], v140 offset:0
s_waitcnt lgkmcnt(13)
ds_read_b64_tr_b16 v[218:219], v141 offset:0
s_add_u32 m0, s43, 81920
s_mov_b32 s44, 360448
s_waitcnt vmcnt(8)
buffer_load_dwordx4 v2, s[72:75], s44 offen  lds
s_waitcnt vmcnt(8)
buffer_load_dwordx4 v3, s[72:75], s44 offen offset:1024  lds
s_waitcnt lgkmcnt(13)
ds_read_b64_tr_b16 v[208:209], v138 offset:8192
s_waitcnt lgkmcnt(13)
ds_read_b64_tr_b16 v[212:213], v139 offset:8192
s_waitcnt lgkmcnt(13)
ds_read_b64_tr_b16 v[216:217], v140 offset:8192
s_waitcnt lgkmcnt(13)
ds_read_b64_tr_b16 v[220:221], v141 offset:8192
s_add_u32 m0, s43, 90112
s_mov_b32 s44, 376832
s_waitcnt vmcnt(8)
buffer_load_dwordx4 v2, s[72:75], s44 offen  lds
s_waitcnt vmcnt(8)
buffer_load_dwordx4 v3, s[72:75], s44 offen offset:1024  lds
s_add_u32 m0, s43, 0
s_mov_b32 s44, 32768
s_waitcnt vmcnt(8)
buffer_load_dwordx4 v2, s[72:75], s44 offen  lds
s_waitcnt vmcnt(8)
buffer_load_dwordx4 v3, s[72:75], s44 offen offset:1024  lds
s_add_u32 m0, s43, 8192
s_mov_b32 s44, 49152
s_waitcnt vmcnt(8)
buffer_load_dwordx4 v2, s[72:75], s44 offen  lds
s_waitcnt vmcnt(8)
buffer_load_dwordx4 v3, s[72:75], s44 offen offset:1024  lds
s_add_u32 m0, s43, 49152
s_mov_b32 s44, 229376
s_waitcnt vmcnt(8)
buffer_load_dwordx4 v2, s[72:75], s44 offen  lds
s_waitcnt vmcnt(8)
buffer_load_dwordx4 v3, s[72:75], s44 offen offset:1024  lds
s_add_u32 m0, s43, 57344
s_mov_b32 s44, 245760
s_waitcnt vmcnt(8)
buffer_load_dwordx4 v2, s[72:75], s44 offen  lds
s_waitcnt vmcnt(8)
buffer_load_dwordx4 v3, s[72:75], s44 offen offset:1024  lds
s_waitcnt lgkmcnt(12)
s_add_u32 m0, s43, 16384
s_mov_b32 s44, 98304
s_waitcnt vmcnt(8)
buffer_load_dwordx4 v2, s[72:75], s44 offen  lds
s_waitcnt vmcnt(8)
buffer_load_dwordx4 v3, s[72:75], s44 offen offset:1024  lds
s_load_dword s16, s[30:31], s98 glc
s_waitcnt lgkmcnt(8)
s_add_u32 m0, s43, 24576
s_mov_b32 s44, 114688
s_waitcnt vmcnt(8)
buffer_load_dwordx4 v2, s[72:75], s44 offen  lds
s_waitcnt vmcnt(8)
buffer_load_dwordx4 v3, s[72:75], s44 offen offset:1024  lds
s_waitcnt lgkmcnt(4)
s_add_u32 m0, s43, 65536
s_mov_b32 s44, 294912
s_waitcnt vmcnt(8)
buffer_load_dwordx4 v2, s[72:75], s44 offen  lds
s_waitcnt vmcnt(8)
buffer_load_dwordx4 v3, s[72:75], s44 offen offset:1024  lds
s_waitcnt lgkmcnt(0)
s_add_u32 m0, s43, 73728
s_mov_b32 s44, 311296
s_waitcnt vmcnt(8)
buffer_load_dwordx4 v2, s[72:75], s44 offen  lds
s_waitcnt vmcnt(8)
buffer_load_dwordx4 v3, s[72:75], s44 offen offset:1024  lds
L_Xk:
s_setprio 0
s_mov_b32 s94, 0
s_waitcnt lgkmcnt(0)
s_and_b32 s16, s16, 255
s_cmp_lg_u32 s16, 7
s_cbranch_scc1 Lsc_23
Lscb_24:
s_mov_b32 s56, 0
buffer_load_dwordx4 v[78:81], v8, s[64:67], s56 offen sc1
s_mov_b32 s57, 4096
buffer_load_dwordx4 v[82:85], v8, s[64:67], s57 offen sc1
buffer_load_dwordx4 v[86:89], v8, s[64:67], s56 offen offset:1024 sc1
buffer_load_dwordx4 v[90:93], v8, s[64:67], s57 offen offset:1024 sc1
buffer_load_dwordx4 v[94:97], v8, s[64:67], s56 offen offset:2048 sc1
buffer_load_dwordx4 v[98:101], v8, s[64:67], s57 offen offset:2048 sc1
buffer_load_dwordx4 v[102:105], v8, s[64:67], s56 offen offset:3072 sc1
buffer_load_dwordx4 v[106:109], v8, s[64:67], s57 offen offset:3072 sc1
s_mov_b32 s56, 8192
buffer_load_dwordx4 v[110:113], v8, s[64:67], s56 offen sc1
s_mov_b32 s57, 12288
buffer_load_dwordx4 v[114:117], v8, s[64:67], s57 offen sc1
buffer_load_dwordx4 v[118:121], v8, s[64:67], s56 offen offset:1024 sc1
buffer_load_dwordx4 v[122:125], v8, s[64:67], s57 offen offset:1024 sc1
s_waitcnt vmcnt(11)
v_mfma_f32_16x16x32_bf16 v[14:17], v[78:81], v[142:145], 0
s_waitcnt vmcnt(10)
v_mfma_f32_16x16x32_bf16 v[14:17], v[82:85], v[158:161], v[14:17]
buffer_load_dwordx4 v[126:129], v8, s[64:67], s56 offen offset:2048 sc1
v_mfma_f32_16x16x32_bf16 v[18:21], v[78:81], v[146:149], 0
v_mfma_f32_16x16x32_bf16 v[18:21], v[82:85], v[162:165], v[18:21]
v_mfma_f32_16x16x32_bf16 v[22:25], v[78:81], v[150:153], 0
v_mfma_f32_16x16x32_bf16 v[22:25], v[82:85], v[166:169], v[22:25]
buffer_load_dwordx4 v[130:133], v8, s[64:67], s57 offen offset:2048 sc1
v_mfma_f32_16x16x32_bf16 v[26:29], v[78:81], v[154:157], 0
v_mfma_f32_16x16x32_bf16 v[26:29], v[82:85], v[170:173], v[26:29]
s_waitcnt vmcnt(11)
v_mfma_f32_16x16x32_bf16 v[30:33], v[86:89], v[142:145], 0
s_waitcnt vmcnt(10)
v_mfma_f32_16x16x32_bf16 v[30:33], v[90:93], v[158:161], v[30:33]
buffer_load_dwordx4 v[134:137], v8, s[64:67], s56 offen offset:3072 sc1
v_mfma_f32_16x16x32_bf16 v[34:37], v[86:89], v[146:149], 0
v_mfma_f32_16x16x32_bf16 v[34:37], v[90:93], v[162:165], v[34:37]
v_mfma_f32_16x16x32_bf16 v[38:41], v[86:89], v[150:153], 0
v_mfma_f32_16x16x32_bf16 v[38:41], v[90:93], v[166:169], v[38:41]
buffer_load_dwordx4 v[78:81], v8, s[64:67], s57 offen offset:3072 sc1
v_mfma_f32_16x16x32_bf16 v[42:45], v[86:89], v[154:157], 0
v_mfma_f32_16x16x32_bf16 v[42:45], v[90:93], v[170:173], v[42:45]
s_waitcnt vmcnt(11)
v_mfma_f32_16x16x32_bf16 v[46:49], v[94:97], v[142:145], 0
s_waitcnt vmcnt(10)
v_mfma_f32_16x16x32_bf16 v[46:49], v[98:101], v[158:161], v[46:49]
s_mov_b32 s56, 16384
buffer_load_dwordx4 v[82:85], v8, s[64:67], s56 offen sc1
v_mfma_f32_16x16x32_bf16 v[50:53], v[94:97], v[146:149], 0
v_mfma_f32_16x16x32_bf16 v[50:53], v[98:101], v[162:165], v[50:53]
v_mfma_f32_16x16x32_bf16 v[54:57], v[94:97], v[150:153], 0
v_mfma_f32_16x16x32_bf16 v[54:57], v[98:101], v[166:169], v[54:57]
s_load_dword s16, s[30:31], s98 glc
s_mov_b32 s57, 20480
buffer_load_dwordx4 v[86:89], v8, s[64:67], s57 offen sc1
v_mfma_f32_16x16x32_bf16 v[58:61], v[94:97], v[154:157], 0
v_mfma_f32_16x16x32_bf16 v[58:61], v[98:101], v[170:173], v[58:61]
s_waitcnt vmcnt(11)
v_mfma_f32_16x16x32_bf16 v[62:65], v[102:105], v[142:145], 0
s_waitcnt vmcnt(10)
v_mfma_f32_16x16x32_bf16 v[62:65], v[106:109], v[158:161], v[62:65]
buffer_load_dwordx4 v[90:93], v8, s[64:67], s56 offen offset:1024 sc1
v_mfma_f32_16x16x32_bf16 v[66:69], v[102:105], v[146:149], 0
v_mfma_f32_16x16x32_bf16 v[66:69], v[106:109], v[162:165], v[66:69]
v_mfma_f32_16x16x32_bf16 v[70:73], v[102:105], v[150:153], 0
v_mfma_f32_16x16x32_bf16 v[70:73], v[106:109], v[166:169], v[70:73]
buffer_load_dwordx4 v[94:97], v8, s[64:67], s57 offen offset:1024 sc1
v_mfma_f32_16x16x32_bf16 v[74:77], v[102:105], v[154:157], 0
v_mfma_f32_16x16x32_bf16 v[74:77], v[106:109], v[170:173], v[74:77]
s_waitcnt vmcnt(11)
v_mfma_f32_16x16x32_bf16 v[14:17], v[110:113], v[174:177], v[14:17]
ds_read_b64_tr_b16 v[142:143], v4 offset:0
s_waitcnt vmcnt(10)
v_mfma_f32_16x16x32_bf16 v[14:17], v[114:117], v[190:193], v[14:17]
ds_read_b64_tr_b16 v[146:147], v5 offset:0
buffer_load_dwordx4 v[98:101], v8, s[64:67], s56 offen offset:2048 sc1
v_mfma_f32_16x16x32_bf16 v[18:21], v[110:113], v[178:181], v[18:21]
ds_read_b64_tr_b16 v[150:151], v6 offset:0
v_mfma_f32_16x16x32_bf16 v[18:21], v[114:117], v[194:197], v[18:21]
ds_read_b64_tr_b16 v[154:155], v7 offset:0
v_mfma_f32_16x16x32_bf16 v[22:25], v[110:113], v[182:185], v[22:25]
ds_read_b64_tr_b16 v[144:145], v4 offset:8192
v_mfma_f32_16x16x32_bf16 v[22:25], v[114:117], v[198:201], v[22:25]
ds_read_b64_tr_b16 v[148:149], v5 offset:8192
buffer_load_dwordx4 v[102:105], v8, s[64:67], s57 offen offset:2048 sc1
v_mfma_f32_16x16x32_bf16 v[26:29], v[110:113], v[186:189], v[26:29]
ds_read_b64_tr_b16 v[152:153], v6 offset:8192
v_mfma_f32_16x16x32_bf16 v[26:29], v[114:117], v[202:205], v[26:29]
ds_read_b64_tr_b16 v[156:157], v7 offset:8192
s_waitcnt vmcnt(11)
v_mfma_f32_16x16x32_bf16 v[30:33], v[118:121], v[174:177], v[30:33]
ds_read_b64_tr_b16 v[158:159], v4 offset:16384
s_waitcnt vmcnt(10)
v_mfma_f32_16x16x32_bf16 v[30:33], v[122:125], v[190:193], v[30:33]
ds_read_b64_tr_b16 v[162:163], v5 offset:16384
buffer_load_dwordx4 v[106:109], v8, s[64:67], s56 offen offset:3072 sc1
v_mfma_f32_16x16x32_bf16 v[34:37], v[118:121], v[178:181], v[34:37]
ds_read_b64_tr_b16 v[166:167], v6 offset:16384
v_mfma_f32_16x16x32_bf16 v[34:37], v[122:125], v[194:197], v[34:37]
ds_read_b64_tr_b16 v[170:171], v7 offset:16384
v_mfma_f32_16x16x32_bf16 v[38:41], v[118:121], v[182:185], v[38:41]
ds_read_b64_tr_b16 v[160:161], v4 offset:24576
v_mfma_f32_16x16x32_bf16 v[38:41], v[122:125], v[198:201], v[38:41]
ds_read_b64_tr_b16 v[164:165], v5 offset:24576
buffer_load_dwordx4 v[110:113], v8, s[64:67], s57 offen offset:3072 sc1
v_mfma_f32_16x16x32_bf16 v[42:45], v[118:121], v[186:189], v[42:45]
s_waitcnt lgkmcnt(13)
ds_read_b64_tr_b16 v[168:169], v6 offset:24576
v_mfma_f32_16x16x32_bf16 v[42:45], v[122:125], v[202:205], v[42:45]
s_waitcnt lgkmcnt(13)
ds_read_b64_tr_b16 v[172:173], v7 offset:24576
s_waitcnt vmcnt(11)
v_mfma_f32_16x16x32_bf16 v[46:49], v[126:129], v[174:177], v[46:49]
s_waitcnt vmcnt(10)
v_mfma_f32_16x16x32_bf16 v[46:49], v[130:133], v[190:193], v[46:49]
s_mov_b32 s56, 24576
buffer_load_dwordx4 v[114:117], v8, s[64:67], s56 offen sc1
v_mfma_f32_16x16x32_bf16 v[50:53], v[126:129], v[178:181], v[50:53]
v_mfma_f32_16x16x32_bf16 v[50:53], v[130:133], v[194:197], v[50:53]
v_mfma_f32_16x16x32_bf16 v[54:57], v[126:129], v[182:185], v[54:57]
v_mfma_f32_16x16x32_bf16 v[54:57], v[130:133], v[198:201], v[54:57]
s_mov_b32 s94, 0
s_waitcnt lgkmcnt(0)
s_cmp_lg_u32 s16, 1799
s_cbranch_scc1 Lsc_25
Lscb_26:
s_mov_b32 s57, 114688
buffer_load_dwordx4 v[118:121], v8, s[64:67], s57 offen sc1
v_mfma_f32_16x16x32_bf16 v[58:61], v[126:129], v[186:189], v[58:61]
v_mfma_f32_16x16x32_bf16 v[58:61], v[130:133], v[202:205], v[58:61]
s_waitcnt vmcnt(11)
v_mfma_f32_16x16x32_bf16 v[62:65], v[134:137], v[174:177], v[62:65]
s_waitcnt vmcnt(10)
v_mfma_f32_16x16x32_bf16 v[62:65], v[78:81], v[190:193], v[62:65]
buffer_load_dwordx4 v[122:125], v8, s[64:67], s56 offen offset:1024 sc1
v_mfma_f32_16x16x32_bf16 v[66:69], v[134:137], v[178:181], v[66:69]
v_mfma_f32_16x16x32_bf16 v[66:69], v[78:81], v[194:197], v[66:69]
v_mfma_f32_16x16x32_bf16 v[70:73], v[134:137], v[182:185], v[70:73]
v_mfma_f32_16x16x32_bf16 v[70:73], v[78:81], v[198:201], v[70:73]
buffer_load_dwordx4 v[126:129], v8, s[64:67], s57 offen offset:1024 sc1
v_mfma_f32_16x16x32_bf16 v[74:77], v[134:137], v[186:189], v[74:77]
v_mfma_f32_16x16x32_bf16 v[74:77], v[78:81], v[202:205], v[74:77]
s_waitcnt vmcnt(11)
v_mfma_f32_16x16x32_bf16 v[14:17], v[82:85], v[206:209], v[14:17]
ds_read_b64_tr_b16 v[174:175], v4 offset:32768
s_waitcnt vmcnt(10)
v_mfma_f32_16x16x32_bf16 v[14:17], v[86:89], v[222:225], v[14:17]
ds_read_b64_tr_b16 v[178:179], v5 offset:32768
buffer_load_dwordx4 v[130:133], v8, s[64:67], s56 offen offset:2048 sc1
v_mfma_f32_16x16x32_bf16 v[18:21], v[82:85], v[210:213], v[18:21]
ds_read_b64_tr_b16 v[182:183], v6 offset:32768
v_mfma_f32_16x16x32_bf16 v[18:21], v[86:89], v[226:229], v[18:21]
ds_read_b64_tr_b16 v[186:187], v7 offset:32768
v_mfma_f32_16x16x32_bf16 v[22:25], v[82:85], v[214:217], v[22:25]
ds_read_b64_tr_b16 v[176:177], v4 offset:40960
v_mfma_f32_16x16x32_bf16 v[22:25], v[86:89], v[230:233], v[22:25]
ds_read_b64_tr_b16 v[180:181], v5 offset:40960
buffer_load_dwordx4 v[134:137], v8, s[64:67], s57 offen offset:2048 sc1
v_mfma_f32_16x16x32_bf16 v[26:29], v[82:85], v[218:221], v[26:29]
ds_read_b64_tr_b16 v[184:185], v6 offset:40960
v_mfma_f32_16x16x32_bf16 v[26:29], v[86:89], v[234:237], v[26:29]
ds_read_b64_tr_b16 v[188:189], v7 offset:40960
s_waitcnt vmcnt(11)
v_mfma_f32_16x16x32_bf16 v[30:33], v[90:93], v[206:209], v[30:33]
ds_read_b64_tr_b16 v[190:191], v4 offset:49152
s_waitcnt vmcnt(10)
v_mfma_f32_16x16x32_bf16 v[30:33], v[94:97], v[222:225], v[30:33]
ds_read_b64_tr_b16 v[194:195], v5 offset:49152
buffer_load_dwordx4 v[78:81], v8, s[64:67], s56 offen offset:3072 sc1
v_mfma_f32_16x16x32_bf16 v[34:37], v[90:93], v[210:213], v[34:37]
ds_read_b64_tr_b16 v[198:199], v6 offset:49152
v_mfma_f32_16x16x32_bf16 v[34:37], v[94:97], v[226:229], v[34:37]
ds_read_b64_tr_b16 v[202:203], v7 offset:49152
v_mfma_f32_16x16x32_bf16 v[38:41], v[90:93], v[214:217], v[38:41]
ds_read_b64_tr_b16 v[192:193], v4 offset:57344
v_mfma_f32_16x16x32_bf16 v[38:41], v[94:97], v[230:233], v[38:41]
ds_read_b64_tr_b16 v[196:197], v5 offset:57344
buffer_load_dwordx4 v[82:85], v8, s[64:67], s57 offen offset:3072 sc1
v_mfma_f32_16x16x32_bf16 v[42:45], v[90:93], v[218:221], v[42:45]
s_waitcnt lgkmcnt(13)
ds_read_b64_tr_b16 v[200:201], v6 offset:57344
v_mfma_f32_16x16x32_bf16 v[42:45], v[94:97], v[234:237], v[42:45]
s_waitcnt lgkmcnt(13)
ds_read_b64_tr_b16 v[204:205], v7 offset:57344
s_waitcnt vmcnt(11)
v_mfma_f32_16x16x32_bf16 v[46:49], v[98:101], v[206:209], v[46:49]
s_waitcnt vmcnt(10)
v_mfma_f32_16x16x32_bf16 v[46:49], v[102:105], v[222:225], v[46:49]
s_mov_b32 s56, 118784
buffer_load_dwordx4 v[86:89], v8, s[64:67], s56 offen sc1
v_mfma_f32_16x16x32_bf16 v[50:53], v[98:101], v[210:213], v[50:53]
v_mfma_f32_16x16x32_bf16 v[50:53], v[102:105], v[226:229], v[50:53]
v_mfma_f32_16x16x32_bf16 v[54:57], v[98:101], v[214:217], v[54:57]
v_mfma_f32_16x16x32_bf16 v[54:57], v[102:105], v[230:233], v[54:57]
s_mov_b32 s57, 122880
buffer_load_dwordx4 v[90:93], v8, s[64:67], s57 offen sc1
v_mfma_f32_16x16x32_bf16 v[58:61], v[98:101], v[218:221], v[58:61]
v_mfma_f32_16x16x32_bf16 v[58:61], v[102:105], v[234:237], v[58:61]
s_waitcnt vmcnt(11)
v_mfma_f32_16x16x32_bf16 v[62:65], v[106:109], v[206:209], v[62:65]
s_waitcnt vmcnt(10)
v_mfma_f32_16x16x32_bf16 v[62:65], v[110:113], v[222:225], v[62:65]
s_mov_b32 s56, 126976
buffer_load_dwordx4 v[94:97], v8, s[64:67], s56 offen sc1
v_mfma_f32_16x16x32_bf16 v[66:69], v[106:109], v[210:213], v[66:69]
v_mfma_f32_16x16x32_bf16 v[66:69], v[110:113], v[226:229], v[66:69]
v_mfma_f32_16x16x32_bf16 v[70:73], v[106:109], v[214:217], v[70:73]
v_mfma_f32_16x16x32_bf16 v[70:73], v[110:113], v[230:233], v[70:73]
s_mov_b32 s57, 131072
buffer_load_dwordx4 v[98:101], v8, s[64:67], s57 offen sc1
v_mfma_f32_16x16x32_bf16 v[74:77], v[106:109], v[218:221], v[74:77]
v_mfma_f32_16x16x32_bf16 v[74:77], v[110:113], v[234:237], v[74:77]
s_waitcnt vmcnt(11)
v_mfma_f32_16x16x32_bf16 v[14:17], v[114:117], v[238:241], v[14:17]
s_waitcnt lgkmcnt(13)
ds_read_b64_tr_b16 v[206:207], v138 offset:0
s_waitcnt vmcnt(10)
v_mfma_f32_16x16x32_bf16 v[14:17], v[118:121], v[142:145], v[14:17]
s_waitcnt lgkmcnt(13)
ds_read_b64_tr_b16 v[210:211], v139 offset:0
s_mov_b32 s56, 135168
buffer_load_dwordx4 v[102:105], v8, s[64:67], s56 offen sc1
v_mfma_f32_16x16x32_bf16 v[18:21], v[114:117], v[242:245], v[18:21]
s_waitcnt lgkmcnt(13)
ds_read_b64_tr_b16 v[214:215], v140 offset:0
v_mfma_f32_16x16x32_bf16 v[18:21], v[118:121], v[146:149], v[18:21]
s_waitcnt lgkmcnt(13)
ds_read_b64_tr_b16 v[218:219], v141 offset:0
v_mfma_f32_16x16x32_bf16 v[22:25], v[114:117], v[246:249], v[22:25]
s_waitcnt lgkmcnt(13)
ds_read_b64_tr_b16 v[208:209], v138 offset:8192
v_mfma_f32_16x16x32_bf16 v[22:25], v[118:121], v[150:153], v[22:25]
s_waitcnt lgkmcnt(13)
ds_read_b64_tr_b16 v[212:213], v139 offset:8192
s_mov_b32 s57, 139264
buffer_load_dwordx4 v[106:109], v8, s[64:67], s57 offen sc1
v_mfma_f32_16x16x32_bf16 v[26:29], v[114:117], v[250:253], v[26:29]
s_waitcnt lgkmcnt(13)
ds_read_b64_tr_b16 v[216:217], v140 offset:8192
v_mfma_f32_16x16x32_bf16 v[26:29], v[118:121], v[154:157], v[26:29]
s_waitcnt lgkmcnt(13)
ds_read_b64_tr_b16 v[220:221], v141 offset:8192
s_waitcnt vmcnt(11)
v_mfma_f32_16x16x32_bf16 v[30:33], v[122:125], v[238:241], v[30:33]
s_waitcnt lgkmcnt(13)
ds_read_b64_tr_b16 v[222:223], v138 offset:16384
s_waitcnt vmcnt(10)
v_mfma_f32_16x16x32_bf16 v[30:33], v[126:129], v[142:145], v[30:33]
s_waitcnt lgkmcnt(13)
ds_read_b64_tr_b16 v[226:227], v139 offset:16384
s_mov_b32 s56, 118784
buffer_load_dwordx4 v[110:113], v8, s[64:67], s56 offen offset:1024 sc1
v_mfma_f32_16x16x32_bf16 v[34:37], v[122:125], v[242:245], v[34:37]
s_waitcnt lgkmcnt(13)
ds_read_b64_tr_b16 v[230:231], v140 offset:16384
v_mfma_f32_16x16x32_bf16 v[34:37], v[126:129], v[146:149], v[34:37]
s_waitcnt lgkmcnt(13)
ds_read_b64_tr_b16 v[234:235], v141 offset:16384
v_mfma_f32_16x16x32_bf16 v[38:41], v[122:125], v[246:249], v[38:41]
s_waitcnt lgkmcnt(13)
ds_read_b64_tr_b16 v[224:225], v138 offset:24576
v_mfma_f32_16x16x32_bf16 v[38:41], v[126:129], v[150:153], v[38:41]
s_waitcnt lgkmcnt(13)
ds_read_b64_tr_b16 v[228:229], v139 offset:24576
s_mov_b32 s57, 122880
buffer_load_dwordx4 v[114:117], v8, s[64:67], s57 offen offset:1024 sc1
v_mfma_f32_16x16x32_bf16 v[42:45], v[122:125], v[250:253], v[42:45]
s_waitcnt lgkmcnt(13)
ds_read_b64_tr_b16 v[232:233], v140 offset:24576
v_mfma_f32_16x16x32_bf16 v[42:45], v[126:129], v[154:157], v[42:45]
s_waitcnt lgkmcnt(13)
ds_read_b64_tr_b16 v[236:237], v141 offset:24576
s_waitcnt vmcnt(11)
v_mfma_f32_16x16x32_bf16 v[46:49], v[130:133], v[238:241], v[46:49]
s_waitcnt vmcnt(10)
v_mfma_f32_16x16x32_bf16 v[46:49], v[134:137], v[142:145], v[46:49]
s_mov_b32 s56, 126976
buffer_load_dwordx4 v[118:121], v8, s[64:67], s56 offen offset:1024 sc1
v_mfma_f32_16x16x32_bf16 v[50:53], v[130:133], v[242:245], v[50:53]
v_mfma_f32_16x16x32_bf16 v[50:53], v[134:137], v[146:149], v[50:53]
v_mfma_f32_16x16x32_bf16 v[54:57], v[130:133], v[246:249], v[54:57]
v_mfma_f32_16x16x32_bf16 v[54:57], v[134:137], v[150:153], v[54:57]
s_mov_b32 s57, 131072
buffer_load_dwordx4 v[122:125], v8, s[64:67], s57 offen offset:1024 sc1
v_mfma_f32_16x16x32_bf16 v[58:61], v[130:133], v[250:253], v[58:61]
v_mfma_f32_16x16x32_bf16 v[58:61], v[134:137], v[154:157], v[58:61]
s_waitcnt vmcnt(11)
v_mfma_f32_16x16x32_bf16 v[62:65], v[78:81], v[238:241], v[62:65]
s_waitcnt vmcnt(10)
v_mfma_f32_16x16x32_bf16 v[62:65], v[82:85], v[142:145], v[62:65]
s_mov_b32 s56, 135168
buffer_load_dwordx4 v[126:129], v8, s[64:67], s56 offen offset:1024 sc1
v_mfma_f32_16x16x32_bf16 v[66:69], v[78:81], v[242:245], v[66:69]
v_mfma_f32_16x16x32_bf16 v[66:69], v[82:85], v[146:149], v[66:69]
v_mfma_f32_16x16x32_bf16 v[70:73], v[78:81], v[246:249], v[70:73]
v_mfma_f32_16x16x32_bf16 v[70:73], v[82:85], v[150:153], v[70:73]
s_mov_b32 s57, 139264
buffer_load_dwordx4 v[130:133], v8, s[64:67], s57 offen offset:1024 sc1
v_mfma_f32_16x16x32_bf16 v[74:77], v[78:81], v[250:253], v[74:77]
v_mfma_f32_16x16x32_bf16 v[74:77], v[82:85], v[154:157], v[74:77]
s_waitcnt vmcnt(11)
v_mfma_f32_16x16x32_bf16 v[14:17], v[86:89], v[158:161], v[14:17]
s_waitcnt lgkmcnt(13)
ds_read_b64_tr_b16 v[238:239], v138 offset:32768
s_waitcnt vmcnt(10)
v_mfma_f32_16x16x32_bf16 v[14:17], v[90:93], v[174:177], v[14:17]
s_waitcnt lgkmcnt(13)
ds_read_b64_tr_b16 v[242:243], v139 offset:32768
s_mov_b32 s56, 118784
buffer_load_dwordx4 v[134:137], v8, s[64:67], s56 offen offset:2048 sc1
v_mfma_f32_16x16x32_bf16 v[18:21], v[86:89], v[162:165], v[18:21]
s_waitcnt lgkmcnt(13)
ds_read_b64_tr_b16 v[246:247], v140 offset:32768
v_mfma_f32_16x16x32_bf16 v[18:21], v[90:93], v[178:181], v[18:21]
s_waitcnt lgkmcnt(13)
ds_read_b64_tr_b16 v[250:251], v141 offset:32768
v_mfma_f32_16x16x32_bf16 v[22:25], v[86:89], v[166:169], v[22:25]
s_waitcnt lgkmcnt(13)
ds_read_b64_tr_b16 v[240:241], v138 offset:40960
v_mfma_f32_16x16x32_bf16 v[22:25], v[90:93], v[182:185], v[22:25]
s_waitcnt lgkmcnt(13)
ds_read_b64_tr_b16 v[244:245], v139 offset:40960
s_mov_b32 s57, 122880
buffer_load_dwordx4 v[78:81], v8, s[64:67], s57 offen offset:2048 sc1
v_mfma_f32_16x16x32_bf16 v[26:29], v[86:89], v[170:173], v[26:29]
s_waitcnt lgkmcnt(13)
ds_read_b64_tr_b16 v[248:249], v140 offset:40960
v_mfma_f32_16x16x32_bf16 v[26:29], v[90:93], v[186:189], v[26:29]
s_waitcnt lgkmcnt(13)
ds_read_b64_tr_b16 v[252:253], v141 offset:40960
s_waitcnt vmcnt(11)
v_mfma_f32_16x16x32_bf16 v[14:17], v[94:97], v[190:193], v[14:17]
s_waitcnt vmcnt(10)
v_mfma_f32_16x16x32_bf16 v[14:17], v[98:101], v[206:209], v[14:17]
s_mov_b32 s56, 126976
buffer_load_dwordx4 v[82:85], v8, s[64:67], s56 offen offset:2048 sc1
v_mfma_f32_16x16x32_bf16 v[18:21], v[94:97], v[194:197], v[18:21]
v_mfma_f32_16x16x32_bf16 v[18:21], v[98:101], v[210:213], v[18:21]
v_mfma_f32_16x16x32_bf16 v[22:25], v[94:97], v[198:201], v[22:25]
v_mfma_f32_16x16x32_bf16 v[22:25], v[98:101], v[214:217], v[22:25]
s_mov_b32 s57, 131072
buffer_load_dwordx4 v[86:89], v8, s[64:67], s57 offen offset:2048 sc1
v_mfma_f32_16x16x32_bf16 v[26:29], v[94:97], v[202:205], v[26:29]
v_mfma_f32_16x16x32_bf16 v[26:29], v[98:101], v[218:221], v[26:29]
s_waitcnt vmcnt(11) lgkmcnt(8)
v_mfma_f32_16x16x32_bf16 v[14:17], v[102:105], v[222:225], v[14:17]
s_waitcnt vmcnt(10) lgkmcnt(0)
v_mfma_f32_16x16x32_bf16 v[14:17], v[106:109], v[238:241], v[14:17]
s_mov_b32 s56, 135168
buffer_load_dwordx4 v[90:93], v8, s[64:67], s56 offen offset:2048 sc1
v_mfma_f32_16x16x32_bf16 v[18:21], v[102:105], v[226:229], v[18:21]
v_mfma_f32_16x16x32_bf16 v[18:21], v[106:109], v[242:245], v[18:21]
v_mfma_f32_16x16x32_bf16 v[22:25], v[102:105], v[230:233], v[22:25]
v_mfma_f32_16x16x32_bf16 v[22:25], v[106:109], v[246:249], v[22:25]
s_mov_b32 s57, 139264
buffer_load_dwordx4 v[94:97], v8, s[64:67], s57 offen offset:2048 sc1
v_mfma_f32_16x16x32_bf16 v[26:29], v[102:105], v[234:237], v[26:29]
v_mfma_f32_16x16x32_bf16 v[26:29], v[106:109], v[250:253], v[26:29]
s_waitcnt vmcnt(11)
v_mfma_f32_16x16x32_bf16 v[30:33], v[110:113], v[158:161], v[30:33]
s_waitcnt vmcnt(10)
v_mfma_f32_16x16x32_bf16 v[30:33], v[114:117], v[174:177], v[30:33]
s_mov_b32 s56, 118784
buffer_load_dwordx4 v[98:101], v8, s[64:67], s56 offen offset:3072 sc1
v_mfma_f32_16x16x32_bf16 v[34:37], v[110:113], v[162:165], v[34:37]
s_add_u32 m0, s43, 0
s_nop 0
ds_write_addtid_b32 v14 offset:0
v_mfma_f32_16x16x32_bf16 v[34:37], v[114:117], v[178:181], v[34:37]
ds_write_addtid_b32 v15 offset:256
v_mfma_f32_16x16x32_bf16 v[38:41], v[110:113], v[166:169], v[38:41]
ds_write_addtid_b32 v16 offset:512
v_mfma_f32_16x16x32_bf16 v[38:41], v[114:117], v[182:185], v[38:41]
ds_write_addtid_b32 v17 offset:768
s_mov_b32 s57, 122880
buffer_load_dwordx4 v[102:105], v8, s[64:67], s57 offen offset:3072 sc1
v_mfma_f32_16x16x32_bf16 v[42:45], v[110:113], v[170:173], v[42:45]
ds_write_addtid_b32 v18 offset:8208
v_mfma_f32_16x16x32_bf16 v[42:45], v[114:117], v[186:189], v[42:45]
ds_write_addtid_b32 v19 offset:8464
s_waitcnt vmcnt(11)
v_mfma_f32_16x16x32_bf16 v[30:33], v[118:121], v[190:193], v[30:33]
ds_write_addtid_b32 v20 offset:8720
s_waitcnt vmcnt(10)
v_mfma_f32_16x16x32_bf16 v[30:33], v[122:125], v[206:209], v[30:33]
ds_write_addtid_b32 v21 offset:8976
s_mov_b32 s56, 126976
buffer_load_dwordx4 v[106:109], v8, s[64:67], s56 offen offset:3072 sc1
v_mfma_f32_16x16x32_bf16 v[34:37], v[118:121], v[194:197], v[34:37]
ds_write_addtid_b32 v22 offset:16512
v_mfma_f32_16x16x32_bf16 v[34:37], v[122:125], v[210:213], v[34:37]
ds_write_addtid_b32 v23 offset:16768
v_mfma_f32_16x16x32_bf16 v[38:41], v[118:121], v[198:201], v[38:41]
ds_write_addtid_b32 v24 offset:17024
v_mfma_f32_16x16x32_bf16 v[38:41], v[122:125], v[214:217], v[38:41]
ds_write_addtid_b32 v25 offset:17280
s_mov_b32 s57, 131072
buffer_load_dwordx4 v[110:113], v8, s[64:67], s57 offen offset:3072 sc1
v_mfma_f32_16x16x32_bf16 v[42:45], v[118:121], v[202:205], v[42:45]
ds_write_addtid_b32 v26 offset:24720
v_mfma_f32_16x16x32_bf16 v[42:45], v[122:125], v[218:221], v[42:45]
ds_write_addtid_b32 v27 offset:24976
s_waitcnt vmcnt(11)
v_mfma_f32_16x16x32_bf16 v[30:33], v[126:129], v[222:225], v[30:33]
s_waitcnt lgkmcnt(13)
ds_write_addtid_b32 v28 offset:25232
s_waitcnt vmcnt(10)
v_mfma_f32_16x16x32_bf16 v[30:33], v[130:133], v[238:241], v[30:33]
s_waitcnt lgkmcnt(13)
ds_write_addtid_b32 v29 offset:25488
s_mov_b32 s56, 135168
buffer_load_dwordx4 v[114:117], v8, s[64:67], s56 offen offset:3072 sc1
v_mfma_f32_16x16x32_bf16 v[34:37], v[126:129], v[226:229], v[34:37]
v_mfma_f32_16x16x32_bf16 v[34:37], v[130:133], v[242:245], v[34:37]
v_mfma_f32_16x16x32_bf16 v[38:41], v[126:129], v[230:233], v[38:41]
v_mfma_f32_16x16x32_bf16 v[38:41], v[130:133], v[246:249], v[38:41]
s_mov_b32 s57, 139264
buffer_load_dwordx4 v[118:121], v8, s[64:67], s57 offen offset:3072 sc1
v_mfma_f32_16x16x32_bf16 v[42:45], v[126:129], v[234:237], v[42:45]
v_mfma_f32_16x16x32_bf16 v[42:45], v[130:133], v[250:253], v[42:45]
s_waitcnt vmcnt(11)
v_mfma_f32_16x16x32_bf16 v[46:49], v[134:137], v[158:161], v[46:49]
s_waitcnt vmcnt(10)
v_mfma_f32_16x16x32_bf16 v[46:49], v[78:81], v[174:177], v[46:49]
v_mfma_f32_16x16x32_bf16 v[50:53], v[134:137], v[162:165], v[50:53]
s_waitcnt lgkmcnt(13)
ds_write_addtid_b32 v30 offset:1024
v_mfma_f32_16x16x32_bf16 v[50:53], v[78:81], v[178:181], v[50:53]
s_waitcnt lgkmcnt(13)
ds_write_addtid_b32 v31 offset:1280
v_mfma_f32_16x16x32_bf16 v[54:57], v[134:137], v[166:169], v[54:57]
s_waitcnt lgkmcnt(13)
ds_write_addtid_b32 v32 offset:1536
v_mfma_f32_16x16x32_bf16 v[54:57], v[78:81], v[182:185], v[54:57]
s_waitcnt lgkmcnt(13)
ds_write_addtid_b32 v33 offset:1792
v_mfma_f32_16x16x32_bf16 v[58:61], v[134:137], v[170:173], v[58:61]
s_waitcnt lgkmcnt(13)
ds_write_addtid_b32 v34 offset:32784
v_mfma_f32_16x16x32_bf16 v[58:61], v[78:81], v[186:189], v[58:61]
s_waitcnt lgkmcnt(13)
ds_write_addtid_b32 v35 offset:33040
s_waitcnt vmcnt(9)
v_mfma_f32_16x16x32_bf16 v[46:49], v[82:85], v[190:193], v[46:49]
s_waitcnt lgkmcnt(13)
ds_write_addtid_b32 v36 offset:33296
s_waitcnt vmcnt(8)
v_mfma_f32_16x16x32_bf16 v[46:49], v[86:89], v[206:209], v[46:49]
s_waitcnt lgkmcnt(13)
ds_write_addtid_b32 v37 offset:33552
v_mfma_f32_16x16x32_bf16 v[50:53], v[82:85], v[194:197], v[50:53]
s_waitcnt lgkmcnt(13)
ds_write_addtid_b32 v38 offset:41088
v_mfma_f32_16x16x32_bf16 v[50:53], v[86:89], v[210:213], v[50:53]
s_waitcnt lgkmcnt(13)
ds_write_addtid_b32 v39 offset:41344
v_mfma_f32_16x16x32_bf16 v[54:57], v[82:85], v[198:201], v[54:57]
s_waitcnt lgkmcnt(13)
ds_write_addtid_b32 v40 offset:41600
v_mfma_f32_16x16x32_bf16 v[54:57], v[86:89], v[214:217], v[54:57]
s_waitcnt lgkmcnt(13)
ds_write_addtid_b32 v41 offset:41856
v_mfma_f32_16x16x32_bf16 v[58:61], v[82:85], v[202:205], v[58:61]
s_waitcnt lgkmcnt(13)
ds_write_addtid_b32 v42 offset:49296
v_mfma_f32_16x16x32_bf16 v[58:61], v[86:89], v[218:221], v[58:61]
s_waitcnt lgkmcnt(13)
ds_write_addtid_b32 v43 offset:49552
s_waitcnt vmcnt(7)
v_mfma_f32_16x16x32_bf16 v[46:49], v[90:93], v[222:225], v[46:49]
s_waitcnt lgkmcnt(13)
ds_write_addtid_b32 v44 offset:49808
s_waitcnt vmcnt(6)
v_mfma_f32_16x16x32_bf16 v[46:49], v[94:97], v[238:241], v[46:49]
s_waitcnt lgkmcnt(13)
ds_write_addtid_b32 v45 offset:50064
v_mov_b32 v10, 160128
v_mov_b32 v11, 1
s_mov_b64 exec, 1
s_waitcnt lgkmcnt(13)
ds_add_u32 v10, v11 offset:24
s_mov_b64 exec, -1
v_mfma_f32_16x16x32_bf16 v[50:53], v[90:93], v[226:229], v[50:53]
v_mfma_f32_16x16x32_bf16 v[50:53], v[94:97], v[242:245], v[50:53]
v_mfma_f32_16x16x32_bf16 v[54:57], v[90:93], v[230:233], v[54:57]
v_mfma_f32_16x16x32_bf16 v[54:57], v[94:97], v[246:249], v[54:57]
v_mfma_f32_16x16x32_bf16 v[58:61], v[90:93], v[234:237], v[58:61]
v_mfma_f32_16x16x32_bf16 v[58:61], v[94:97], v[250:253], v[58:61]
s_waitcnt vmcnt(5)
v_mfma_f32_16x16x32_bf16 v[62:65], v[98:101], v[158:161], v[62:65]
s_waitcnt vmcnt(4)
v_mfma_f32_16x16x32_bf16 v[62:65], v[102:105], v[174:177], v[62:65]
v_mfma_f32_16x16x32_bf16 v[66:69], v[98:101], v[162:165], v[66:69]
s_add_u32 m0, s43, 57344
s_nop 0
s_waitcnt lgkmcnt(13)
ds_write_addtid_b32 v46 offset:0
v_mfma_f32_16x16x32_bf16 v[66:69], v[102:105], v[178:181], v[66:69]
s_waitcnt lgkmcnt(13)
ds_write_addtid_b32 v47 offset:256
v_mfma_f32_16x16x32_bf16 v[70:73], v[98:101], v[166:169], v[70:73]
s_waitcnt lgkmcnt(13)
ds_write_addtid_b32 v48 offset:512
v_mfma_f32_16x16x32_bf16 v[70:73], v[102:105], v[182:185], v[70:73]
s_waitcnt lgkmcnt(13)
ds_write_addtid_b32 v49 offset:768
v_mfma_f32_16x16x32_bf16 v[74:77], v[98:101], v[170:173], v[74:77]
s_waitcnt lgkmcnt(13)
ds_write_addtid_b32 v50 offset:8208
v_mfma_f32_16x16x32_bf16 v[74:77], v[102:105], v[186:189], v[74:77]
s_waitcnt lgkmcnt(13)
ds_write_addtid_b32 v51 offset:8464
s_waitcnt vmcnt(3)
v_mfma_f32_16x16x32_bf16 v[62:65], v[106:109], v[190:193], v[62:65]
s_waitcnt lgkmcnt(13)
ds_write_addtid_b32 v52 offset:8720
s_waitcnt vmcnt(2)
v_mfma_f32_16x16x32_bf16 v[62:65], v[110:113], v[206:209], v[62:65]
s_waitcnt lgkmcnt(13)
ds_write_addtid_b32 v53 offset:8976
v_mfma_f32_16x16x32_bf16 v[66:69], v[106:109], v[194:197], v[66:69]
s_waitcnt lgkmcnt(13)
ds_write_addtid_b32 v54 offset:16512
v_mfma_f32_16x16x32_bf16 v[66:69], v[110:113], v[210:213], v[66:69]
s_waitcnt lgkmcnt(13)
ds_write_addtid_b32 v55 offset:16768
v_mfma_f32_16x16x32_bf16 v[70:73], v[106:109], v[198:201], v[70:73]
s_waitcnt lgkmcnt(13)
ds_write_addtid_b32 v56 offset:17024
v_mfma_f32_16x16x32_bf16 v[70:73], v[110:113], v[214:217], v[70:73]
s_waitcnt lgkmcnt(13)
ds_write_addtid_b32 v57 offset:17280
v_mfma_f32_16x16x32_bf16 v[74:77], v[106:109], v[202:205], v[74:77]
s_waitcnt lgkmcnt(13)
ds_write_addtid_b32 v58 offset:24720
v_mfma_f32_16x16x32_bf16 v[74:77], v[110:113], v[218:221], v[74:77]
s_waitcnt lgkmcnt(13)
ds_write_addtid_b32 v59 offset:24976
s_waitcnt vmcnt(1)
v_mfma_f32_16x16x32_bf16 v[62:65], v[114:117], v[222:225], v[62:65]
s_waitcnt lgkmcnt(13)
ds_write_addtid_b32 v60 offset:25232
s_waitcnt vmcnt(0)
v_mfma_f32_16x16x32_bf16 v[62:65], v[118:121], v[238:241], v[62:65]
s_waitcnt lgkmcnt(13)
ds_write_addtid_b32 v61 offset:25488
v_mfma_f32_16x16x32_bf16 v[66:69], v[114:117], v[226:229], v[66:69]
v_mfma_f32_16x16x32_bf16 v[66:69], v[118:121], v[242:245], v[66:69]
v_mfma_f32_16x16x32_bf16 v[70:73], v[114:117], v[230:233], v[70:73]
v_mfma_f32_16x16x32_bf16 v[70:73], v[118:121], v[246:249], v[70:73]
v_mfma_f32_16x16x32_bf16 v[74:77], v[114:117], v[234:237], v[74:77]
v_mfma_f32_16x16x32_bf16 v[74:77], v[118:121], v[250:253], v[74:77]
s_nop 1
s_waitcnt lgkmcnt(13)
ds_write_addtid_b32 v62 offset:1024
s_waitcnt lgkmcnt(13)
ds_write_addtid_b32 v63 offset:1280
s_waitcnt lgkmcnt(13)
ds_write_addtid_b32 v64 offset:1536
s_waitcnt lgkmcnt(13)
ds_write_addtid_b32 v65 offset:1792
s_waitcnt lgkmcnt(13)
ds_write_addtid_b32 v66 offset:32784
s_waitcnt lgkmcnt(13)
ds_write_addtid_b32 v67 offset:33040
s_waitcnt lgkmcnt(13)
ds_write_addtid_b32 v68 offset:33296
s_waitcnt lgkmcnt(13)
ds_write_addtid_b32 v69 offset:33552
s_waitcnt lgkmcnt(13)
ds_write_addtid_b32 v70 offset:41088
s_waitcnt lgkmcnt(13)
ds_write_addtid_b32 v71 offset:41344
s_waitcnt lgkmcnt(13)
ds_write_addtid_b32 v72 offset:41600
s_waitcnt lgkmcnt(13)
ds_write_addtid_b32 v73 offset:41856
s_waitcnt lgkmcnt(13)
ds_write_addtid_b32 v74 offset:49296
s_waitcnt lgkmcnt(13)
ds_write_addtid_b32 v75 offset:49552
s_waitcnt lgkmcnt(13)
ds_write_addtid_b32 v76 offset:49808
s_waitcnt lgkmcnt(13)
ds_write_addtid_b32 v77 offset:50064
s_mov_b64 exec, 1
s_waitcnt lgkmcnt(13)
ds_add_u32 v10, v11 offset:28
s_mov_b64 exec, -1
s_endpgm
L_Xh:
s_add_u32 m0, s43, 99328
s_nop 0
buffer_load_dwordx4 v22, s[52:55], s88 offen nt lds
buffer_load_dwordx4 v23, s[52:55], s88 offen offset:1024 nt lds
s_cmp_eq_u32 s32, 3
s_cbranch_scc1 Lhalo_1
s_lshl_b32 s44, s33, 9
s_lshl_b32 s45, s36, 8
s_cmp_eq_u32 s32, 0
s_cselect_b64 s[46:47], s[10:11], s[20:21]
s_cselect_b32 s44, s44, s45
s_lshl_b32 s45, s39, 7
s_cmp_eq_u32 s32, 2
s_cselect_b64 s[46:47], s[24:25], s[46:47]
s_cselect_b32 s44, s45, s44
v_add_u32 v24, s44, v1
s_lshr_b32 s44, 32, s32
s_lshl_b32 s45, s44, 5
s_sub_u32 m0, 161216, s45
s_bfm_b64 exec, s44, 0
global_load_lds_dwordx4 v24, s[46:47]
s_branch Lsmd_2
Lhalo_1:
s_sub_u32 s44, s88, 57344
s_cselect_b32 s44, 0, s44
s_cselect_b32 s45, 0x80000010, 16
v_xor_b32 v24, s45, v22
s_mov_b32 m0, 98304
s_lshl_b64 exec, -1, 40
buffer_load_dwordx4 v24, s[52:55], s44 offen nt lds
Lsmd_2:
s_add_u32 m0, s43, 107520
s_mov_b64 exec, -1
buffer_load_dwordx4 v22, s[56:59], s88 offen nt lds
buffer_load_dwordx4 v23, s[56:59], s88 offen offset:1024 nt lds
s_waitcnt vmcnt(0)
s_barrier
s_mov_b64 exec, 15
ds_read_b128 v[120:123], v116
s_mov_b64 exec, -1
ds_read_b128 v[108:111], v25
ds_read_b32 v33, v27 offset:640
ds_read2_b32 v[34:35], v27 offset0:192 offset1:224
ds_read2_b32 v[36:37], v26 offset0:0 offset1:32
ds_read2_b32 v[38:39], v26 offset0:64 offset1:96
ds_read2_b32 v[40:41], v26 offset0:128 offset1:160
ds_read2_b32 v[42:43], v26 offset0:192 offset1:224
ds_read2_b32 v[44:45], v28 offset0:0 offset1:32
ds_read2_b32 v[46:47], v28 offset0:64 offset1:96
ds_read2_b32 v[48:49], v28 offset0:128 offset1:160
ds_read2_b32 v[50:51], v28 offset0:192 offset1:224
s_waitcnt lgkmcnt(0)
v_lshlrev_b32 v80, 16, v108
v_and_b32 v81, v117, v108
v_lshlrev_b32 v82, 16, v109
v_and_b32 v83, v117, v109
v_lshlrev_b32 v84, 16, v110
v_and_b32 v85, v117, v110
v_lshlrev_b32 v86, 16, v111
v_and_b32 v87, v117, v111
v_lshlrev_b32 v57, 16, v33
v_lshlrev_b32 v58, 16, v34
v_lshlrev_b32 v59, 16, v35
v_lshlrev_b32 v60, 16, v36
v_lshlrev_b32 v61, 16, v37
v_lshlrev_b32 v62, 16, v38
v_lshlrev_b32 v63, 16, v39
v_lshlrev_b32 v64, 16, v40
v_lshlrev_b32 v65, 16, v41
v_lshlrev_b32 v66, 16, v42
v_lshlrev_b32 v67, 16, v43
v_mul_f32 v100, v57, v83
v_mul_f32 v101, v58, v83
v_mul_f32 v102, v59, v83
v_mul_f32 v103, v60, v83
v_mul_f32 v104, v61, v83
v_mul_f32 v105, v62, v83
v_mul_f32 v106, v63, v83
v_mul_f32 v107, v64, v83
v_fmac_f32 v100, v58, v82
v_fmac_f32 v101, v59, v82
v_fmac_f32 v102, v60, v82
v_fmac_f32 v103, v61, v82
v_fmac_f32 v104, v62, v82
v_fmac_f32 v105, v63, v82
v_fmac_f32 v106, v64, v82
v_fmac_f32 v107, v65, v82
v_fmac_f32 v100, v59, v81
v_fmac_f32 v101, v60, v81
v_fmac_f32 v102, v61, v81
v_fmac_f32 v103, v62, v81
v_fmac_f32 v104, v63, v81
v_fmac_f32 v105, v64, v81
v_fmac_f32 v106, v65, v81
v_fmac_f32 v107, v66, v81
v_fmac_f32 v100, v60, v80
v_fmac_f32 v101, v61, v80
v_fmac_f32 v102, v62, v80
v_fmac_f32 v103, v63, v80
v_fmac_f32 v104, v64, v80
v_fmac_f32 v105, v65, v80
v_fmac_f32 v106, v66, v80
v_fmac_f32 v107, v67, v80
v_lshlrev_b32 v88, 16, v44
v_mul_f32 v100, v100, v88
v_lshlrev_b32 v89, 16, v45
v_mul_f32 v101, v101, v89
v_lshlrev_b32 v88, 16, v46
v_mul_f32 v102, v102, v88
v_lshlrev_b32 v89, 16, v47
v_mul_f32 v103, v103, v89
v_lshlrev_b32 v88, 16, v48
v_mul_f32 v104, v104, v88
v_lshlrev_b32 v89, 16, v49
v_mul_f32 v105, v105, v89
v_lshlrev_b32 v88, 16, v50
v_mul_f32 v106, v106, v88
v_lshlrev_b32 v89, 16, v51
v_mul_f32 v107, v107, v89
v_cvt_pk_bf16_f32 v92, v107, v106
v_cvt_pk_bf16_f32 v93, v105, v104
v_cvt_pk_bf16_f32 v94, v103, v102
v_cvt_pk_bf16_f32 v95, v101, v100
buffer_store_dwordx4 v[92:95], v29, s[64:67], s0 offen sc1
v_and_b32 v57, v117, v33
v_and_b32 v58, v117, v34
v_and_b32 v59, v117, v35
v_and_b32 v60, v117, v36
v_and_b32 v61, v117, v37
v_and_b32 v62, v117, v38
v_and_b32 v63, v117, v39
v_and_b32 v64, v117, v40
v_and_b32 v65, v117, v41
v_and_b32 v66, v117, v42
v_and_b32 v67, v117, v43
v_mul_f32 v100, v57, v87
v_mul_f32 v101, v58, v87
v_mul_f32 v102, v59, v87
v_mul_f32 v103, v60, v87
v_mul_f32 v104, v61, v87
v_mul_f32 v105, v62, v87
v_mul_f32 v106, v63, v87
v_mul_f32 v107, v64, v87
v_fmac_f32 v100, v58, v86
v_fmac_f32 v101, v59, v86
v_fmac_f32 v102, v60, v86
v_fmac_f32 v103, v61, v86
v_fmac_f32 v104, v62, v86
v_fmac_f32 v105, v63, v86
v_fmac_f32 v106, v64, v86
v_fmac_f32 v107, v65, v86
v_fmac_f32 v100, v59, v85
v_fmac_f32 v101, v60, v85
v_fmac_f32 v102, v61, v85
v_fmac_f32 v103, v62, v85
v_fmac_f32 v104, v63, v85
v_fmac_f32 v105, v64, v85
v_fmac_f32 v106, v65, v85
v_fmac_f32 v107, v66, v85
v_fmac_f32 v100, v60, v84
v_fmac_f32 v101, v61, v84
v_fmac_f32 v102, v62, v84
v_fmac_f32 v103, v63, v84
v_fmac_f32 v104, v64, v84
v_fmac_f32 v105, v65, v84
v_fmac_f32 v106, v66, v84
v_fmac_f32 v107, v67, v84
v_and_b32 v88, v117, v44
v_mul_f32 v100, v100, v88
v_and_b32 v89, v117, v45
v_mul_f32 v101, v101, v89
v_and_b32 v88, v117, v46
v_mul_f32 v102, v102, v88
v_and_b32 v89, v117, v47
v_mul_f32 v103, v103, v89
v_and_b32 v88, v117, v48
v_mul_f32 v104, v104, v88
v_and_b32 v89, v117, v49
v_mul_f32 v105, v105, v89
v_and_b32 v88, v117, v50
v_mul_f32 v106, v106, v88
v_and_b32 v89, v117, v51
v_mul_f32 v107, v107, v89
v_cvt_pk_bf16_f32 v96, v107, v106
v_cvt_pk_bf16_f32 v97, v105, v104
v_cvt_pk_bf16_f32 v98, v103, v102
v_cvt_pk_bf16_f32 v99, v101, v100
buffer_store_dwordx4 v[96:99], v29, s[64:67], s1 offen sc1
s_cmp_lg_u32 s32, 0
s_cbranch_scc1 Lmk_3
s_load_dwordx8 s[80:87], s[28:29], 0
Lmk_3:
s_cmp_lg_u32 s32, 0
s_cbranch_scc1 Lmk_4
s_waitcnt lgkmcnt(0)
s_and_b64 s[80:81], s[80:81], s[82:83]
s_and_b64 s[84:85], s[84:85], s[86:87]
s_and_b64 s[80:81], s[80:81], s[84:85]
s_and_b32 s80, s80, s81
s_cbranch_scc1 Lmk_4
s_mov_b32 s94, 0
Lpoll_5:
buffer_load_dword v31, v30, s[68:71], 0 offen sc1
s_waitcnt vmcnt(0)
v_cmp_ne_u32 vcc, 1, v31
s_add_u32 s94, s94, 1
s_cmp_gt_u32 s94, 131072
s_cbranch_scc1 Lpolld_6
s_cbranch_vccnz Lpoll_5
Lpolld_6:
Lmk_4:
s_barrier
s_cmp_lg_u32 s32, 0
s_cbranch_scc1 Lpb_7
s_lshl_b32 s44, s40, 6
s_add_u32 s44, s44, s99
s_mov_b64 exec, 15
buffer_store_dwordx4 v[120:123], v1, s[64:67], s44 offen sc1
s_mov_b64 exec, -1
Lpb_7:
s_and_b32 s44, s2, 31
s_lshl2_add_u32 s44, s44, s32
s_mul_i32 s44, s44, 14336
s_add_u32 s45, s44, 7168
v_lshlrev_b32 v12, 7, v0
s_bfm_b64 exec, 56, 0
buffer_load_dword v112, v12, s[72:75], s44 offen
buffer_load_dword v112, v12, s[72:75], s45 offen
s_mov_b64 exec, -1
s_waitcnt vmcnt(2)
s_movk_i32 s3, 1
s_atomic_add s3, s[30:31], s98
s_mov_b32 m0, s17
s_lshl_b32 s44, s93, 12
buffer_load_dwordx4 v1, s[76:79], s90 offen nt lds
buffer_load_dwordx4 v1, s[76:79], s90 offen offset:1024 nt lds
s_add_u32 s44, s44, 2044
s_load_dword s88, s[12:13], s44
s_add_u32 m0, s43, 98304
s_mov_b32 s44, 393216
buffer_load_dwordx4 v2, s[72:75], s44 offen  lds
buffer_load_dwordx4 v3, s[72:75], s44 offen offset:1024  lds
s_add_u32 m0, s43, 106496
s_mov_b32 s44, 409600
buffer_load_dwordx4 v2, s[72:75], s44 offen  lds
buffer_load_dwordx4 v3, s[72:75], s44 offen offset:1024  lds
s_add_u32 m0, s43, 32768
s_mov_b32 s44, 131072
buffer_load_dwordx4 v2, s[72:75], s44 offen  lds
buffer_load_dwordx4 v3, s[72:75], s44 offen offset:1024  lds
s_add_u32 m0, s43, 40960
s_mov_b32 s44, 147456
buffer_load_dwordx4 v2, s[72:75], s44 offen  lds
buffer_load_dwordx4 v3, s[72:75], s44 offen offset:1024  lds
s_branch L_Xj
Lsc_23:
s_load_dword s16, s[30:31], s98 glc
s_add_u32 s94, s94, 1
s_cmp_gt_u32 s94, 131072
s_waitcnt lgkmcnt(0)
s_cbranch_scc1 Lscb_24
s_and_b32 s16, s16, 255
s_cmp_lg_u32 s16, 7
s_cbranch_scc1 Lsc_23
s_branch Lscb_24
Lsc_25:
s_load_dword s16, s[30:31], s98 glc
s_add_u32 s94, s94, 1
s_cmp_gt_u32 s94, 131072
s_waitcnt lgkmcnt(0)
s_cbranch_scc1 Lscb_26
s_cmp_lg_u32 s16, 1799
s_cbranch_scc1 Lsc_25
s_branch Lscb_26
.p2align 12
L_M2:
s_and_b32 s45, s33, 1
s_sub_u32 s36, s40, s45
s_min_u32 s36, s36, 13
s_and_b32 s45, s33, 1
s_and_b32 s46, s34, 3
s_lshl_b32 s43, s32, 11
s_lshl1_add_u32 s47, s46, s42
s_and_b32 s38, s42, 1
s_lshr_b32 s39, s42, 1
s_xor_b32 s47, s38, 1
s_cmp_lt_u32 s42, 6
s_cselect_b32 s47, s45, s47
s_cselect_b32 s38, s38, s45
s_lshl2_add_u32 s39, s47, s39
s_lshl1_add_u32 s38, s35, s38
s_waitcnt lgkmcnt(0)
s_lshl_b32 s44, s33, 5
s_add_u32 s44, s44, s34
s_lshl_b32 s44, s44, 2
s_load_dword s16, s[14:15], s44
v_bfe_u32 v10, v0, 2, 2
v_mov_b32 v13, 0x3f803f80
v_cmp_eq_u32 vcc, 0, v10
s_nop 1
v_cndmask_b32 v80, 0, v13, vcc
v_cndmask_b32 v81, 0, v13, vcc
v_cndmask_b32 v82, 0, v13, vcc
v_cndmask_b32 v83, 0, v13, vcc
v_cmp_eq_u32 vcc, 1, v10
s_nop 1
v_cndmask_b32 v84, 0, v13, vcc
v_cndmask_b32 v85, 0, v13, vcc
v_cndmask_b32 v86, 0, v13, vcc
v_cndmask_b32 v87, 0, v13, vcc
v_cmp_eq_u32 vcc, 2, v10
s_nop 1
v_cndmask_b32 v88, 0, v13, vcc
v_cndmask_b32 v89, 0, v13, vcc
v_cndmask_b32 v90, 0, v13, vcc
v_cndmask_b32 v91, 0, v13, vcc
v_cmp_eq_u32 vcc, 3, v10
s_nop 1
v_cndmask_b32 v92, 0, v13, vcc
v_cndmask_b32 v93, 0, v13, vcc
v_cndmask_b32 v94, 0, v13, vcc
v_cndmask_b32 v95, 0, v13, vcc
v_lshrrev_b32 v10, 3, v0
v_and_b32 v11, 1, v10
v_bfe_u32 v12, v10, 1, 1
v_lshl_add_u32 v11, v12, 2, v11
v_lshrrev_b32 v12, 2, v10
v_lshl_add_u32 v11, v12, 1, v11
s_and_b32 s44, s38, 1
s_lshl_b32 s44, s44, 6
s_lshl3_add_u32 s44, s32, s44
v_add_u32 v11, s44, v11
v_lshrrev_b32 v12, 1, v11
v_xor_b32 v12, v12, v0
v_and_b32 v12, 7, v12
v_lshlrev_b32 v12, 4, v12
v_lshl_add_u32 v252, v11, 7, v12
s_sub_u32 s92, s39, s37
s_and_b32 s92, s92, 7
s_waitcnt vmcnt(0)
v_lshlrev_b32 v104, 16, v96
v_and_b32 v105, 0xffff0000, v96
v_lshlrev_b32 v106, 16, v97
v_and_b32 v107, 0xffff0000, v97
v_lshlrev_b32 v108, 16, v98
v_and_b32 v109, 0xffff0000, v98
v_lshlrev_b32 v110, 16, v99
v_and_b32 v111, 0xffff0000, v99
v_lshlrev_b32 v112, 16, v100
v_and_b32 v113, 0xffff0000, v100
v_lshlrev_b32 v114, 16, v101
v_and_b32 v115, 0xffff0000, v101
v_lshlrev_b32 v116, 16, v102
v_and_b32 v117, 0xffff0000, v102
v_lshlrev_b32 v118, 16, v103
v_and_b32 v119, 0xffff0000, v103
v_add_f32 v96, v104, v105
v_add_f32 v97, v112, v113
v_add_f32 v96, v96, v106
v_add_f32 v97, v97, v114
v_add_f32 v96, v96, v107
v_add_f32 v97, v97, v115
v_add_f32 v96, v96, v108
v_add_f32 v97, v97, v116
v_add_f32 v96, v96, v109
v_add_f32 v97, v97, v117
v_add_f32 v96, v96, v110
v_add_f32 v97, v97, v118
v_add_f32 v96, v96, v111
v_add_f32 v97, v97, v119
s_nop 0
v_add_f32_dpp v96, v96, v96 row_shr:1 row_mask:0xf bank_mask:0xf bound_ctrl:0
v_add_f32_dpp v97, v97, v97 row_shr:1 row_mask:0xf bank_mask:0xf bound_ctrl:0
s_nop 0
v_add_f32_dpp v96, v96, v96 row_shr:2 row_mask:0xf bank_mask:0xf bound_ctrl:0
v_add_f32_dpp v97, v97, v97 row_shr:2 row_mask:0xf bank_mask:0xf bound_ctrl:0
s_nop 0
v_add_f32_dpp v96, v96, v96 row_shr:4 row_mask:0xf bank_mask:0xf bound_ctrl:0
v_add_f32_dpp v97, v97, v97 row_shr:4 row_mask:0xf bank_mask:0xf bound_ctrl:0
s_nop 0
v_add_f32_dpp v96, v96, v96 row_shr:8 row_mask:0xf bank_mask:0xf bound_ctrl:0
v_add_f32_dpp v97, v97, v97 row_shr:8 row_mask:0xf bank_mask:0xf bound_ctrl:0
s_nop 0
v_add_f32_dpp v96, v96, v96 row_bcast:15 row_mask:0xa bank_mask:0xf
v_add_f32_dpp v97, v97, v97 row_bcast:15 row_mask:0xa bank_mask:0xf
s_nop 0
v_add_f32_dpp v96, v96, v96 row_bcast:31 row_mask:0xc bank_mask:0xf
v_add_f32_dpp v97, v97, v97 row_bcast:31 row_mask:0xc bank_mask:0xf
v_mul_f32 v98, 0x3b000000, v96
v_mul_f32 v99, 0x3b000000, v97
v_readlane_b32 s44, v98, 63
v_readlane_b32 s45, v99, 63
s_nop 0
v_subrev_f32 v104, s44, v104
v_subrev_f32 v105, s44, v105
v_subrev_f32 v106, s44, v106
v_subrev_f32 v107, s44, v107
v_subrev_f32 v108, s44, v108
v_subrev_f32 v109, s44, v109
v_subrev_f32 v110, s44, v110
v_subrev_f32 v111, s44, v111
v_subrev_f32 v112, s45, v112
v_subrev_f32 v113, s45, v113
v_subrev_f32 v114, s45, v114
v_subrev_f32 v115, s45, v115
v_subrev_f32 v116, s45, v116
v_subrev_f32 v117, s45, v117
v_subrev_f32 v118, s45, v118
v_subrev_f32 v119, s45, v119
v_mul_f32 v96, v104, v104
v_mul_f32 v97, v112, v112
v_fmac_f32 v96, v105, v105
v_fmac_f32 v97, v113, v113
v_fmac_f32 v96, v106, v106
v_fmac_f32 v97, v114, v114
v_fmac_f32 v96, v107, v107
v_fmac_f32 v97, v115, v115
v_fmac_f32 v96, v108, v108
v_fmac_f32 v97, v116, v116
v_fmac_f32 v96, v109, v109
v_fmac_f32 v97, v117, v117
v_fmac_f32 v96, v110, v110
v_fmac_f32 v97, v118, v118
v_fmac_f32 v96, v111, v111
v_fmac_f32 v97, v119, v119
s_nop 0
v_add_f32_dpp v96, v96, v96 row_shr:1 row_mask:0xf bank_mask:0xf bound_ctrl:0
v_add_f32_dpp v97, v97, v97 row_shr:1 row_mask:0xf bank_mask:0xf bound_ctrl:0
s_nop 0
v_add_f32_dpp v96, v96, v96 row_shr:2 row_mask:0xf bank_mask:0xf bound_ctrl:0
v_add_f32_dpp v97, v97, v97 row_shr:2 row_mask:0xf bank_mask:0xf bound_ctrl:0
s_nop 0
v_add_f32_dpp v96, v96, v96 row_shr:4 row_mask:0xf bank_mask:0xf bound_ctrl:0
v_add_f32_dpp v97, v97, v97 row_shr:4 row_mask:0xf bank_mask:0xf bound_ctrl:0
s_nop 0
v_add_f32_dpp v96, v96, v96 row_shr:8 row_mask:0xf bank_mask:0xf bound_ctrl:0
v_add_f32_dpp v97, v97, v97 row_shr:8 row_mask:0xf bank_mask:0xf bound_ctrl:0
s_nop 0
v_add_f32_dpp v96, v96, v96 row_bcast:15 row_mask:0xa bank_mask:0xf
v_add_f32_dpp v97, v97, v97 row_bcast:15 row_mask:0xa bank_mask:0xf
s_nop 0
v_add_f32_dpp v96, v96, v96 row_bcast:31 row_mask:0xc bank_mask:0xf
v_add_f32_dpp v97, v97, v97 row_bcast:31 row_mask:0xc bank_mask:0xf
v_mov_b32 v11, 0x3727c5ac
v_fmamk_f32 v96, v96, 0x3b000000, v11
v_fmamk_f32 v97, v97, 0x3b000000, v11
v_rsq_f32 v96, v96
v_rsq_f32 v97, v97
v_or_b32 v248, 1, v98
v_or_b32 v250, 1, v99
v_or_b32 v249, 1, v96
v_or_b32 v251, 1, v97
s_lshl_b32 s44, s32, 4
s_add_u32 s44, s44, 161088
v_mov_b32 v10, s44
s_lshl_b64 exec, -1, 63
ds_write_b128 v10, v[248:251]
s_mov_b64 exec, -1
s_waitcnt lgkmcnt(0)
v_mov_b32 v227, 160128
s_barrier
s_cmp_eq_u32 s42, 7
s_cbranch_scc1 L_Mh
ds_read_b64_tr_b16 v[128:129], v4 offset:0
ds_read_b64_tr_b16 v[130:131], v4 offset:1024
ds_read_b128 v[96:99], v2 offset:0
ds_read_b128 v[100:103], v2 offset:2048
ds_read_b128 v[104:107], v2 offset:4096
ds_read_b128 v[108:111], v2 offset:6144
ds_read_b64_tr_b16 v[132:133], v5 offset:0
ds_read_b64_tr_b16 v[134:135], v5 offset:1024
ds_read_b64_tr_b16 v[136:137], v6 offset:0
ds_read_b64_tr_b16 v[138:139], v6 offset:1024
ds_read_b64_tr_b16 v[140:141], v7 offset:0
ds_read_b64_tr_b16 v[142:143], v7 offset:1024
s_waitcnt lgkmcnt(9)
v_mfma_f32_16x16x32_bf16 v[16:19], v[128:131], v[96:99], 0
ds_read_b64_tr_b16 v[144:145], v204 offset:0
v_lshrrev_b32 v11, 4, v0
s_waitcnt lgkmcnt(9)
v_mfma_f32_16x16x32_bf16 v[20:23], v[128:131], v[100:103], 0
ds_read_b64_tr_b16 v[146:147], v204 offset:1024
s_lshl_b32 s44, s32, 8
s_add_u32 s45, s44, 159104
s_waitcnt lgkmcnt(9)
v_mfma_f32_16x16x32_bf16 v[24:27], v[128:131], v[104:107], 0
ds_read_b128 v[112:115], v3 offset:0
v_lshl_add_u32 v14, v0, 2, s45
s_waitcnt lgkmcnt(9)
v_mfma_f32_16x16x32_bf16 v[28:31], v[128:131], v[108:111], 0
ds_read_b128 v[116:119], v3 offset:2048
s_xor_b32 s44, s44, 256
s_add_u32 s44, s44, 159104
s_waitcnt lgkmcnt(8)
v_mfma_f32_16x16x32_bf16 v[44:47], v[132:135], v[108:111], 0
ds_read_b128 v[120:123], v3 offset:4096
v_and_b32 v15, 60, v0
v_mfma_f32_16x16x32_bf16 v[40:43], v[132:135], v[104:107], 0
ds_read_b128 v[124:127], v3 offset:6144
v_lshl_add_u32 v15, v15, 2, s44
v_mfma_f32_16x16x32_bf16 v[36:39], v[132:135], v[100:103], 0
ds_read_b64_tr_b16 v[148:149], v205 offset:0
s_lshl_b32 s91, s35, 10
s_lshl_b32 s44, s98, 9
v_mfma_f32_16x16x32_bf16 v[32:35], v[132:135], v[96:99], 0
ds_read_b64_tr_b16 v[150:151], v205 offset:1024
s_add_u32 s91, s91, s44
s_add_u32 s91, s91, 131072
s_waitcnt lgkmcnt(10)
v_mfma_f32_16x16x32_bf16 v[48:51], v[136:139], v[96:99], 0
ds_read_b64_tr_b16 v[152:153], v206 offset:0
s_mul_i32 s44, s99, 17600
s_lshl_b32 s45, s98, 8
v_mfma_f32_16x16x32_bf16 v[52:55], v[136:139], v[100:103], 0
ds_read_b64_tr_b16 v[154:155], v206 offset:1024
s_add_u32 s44, s44, s45
s_add_u32 s45, s44, 124608
v_mfma_f32_16x16x32_bf16 v[56:59], v[136:139], v[104:107], 0
ds_read_b64_tr_b16 v[156:157], v207 offset:0
s_add_u32 s44, s44, 115784
v_and_b32 v10, 1, v0
v_mfma_f32_16x16x32_bf16 v[60:63], v[136:139], v[108:111], 0
ds_read_b64_tr_b16 v[158:159], v207 offset:1024
v_bfe_u32 v12, v0, 1, 3
s_waitcnt lgkmcnt(12)
v_mfma_f32_16x16x32_bf16 v[76:79], v[140:143], v[108:111], 0
s_cmp_eq_u32 s92, 0
s_cselect_b64 exec, -1, 0
ds_read_b128 v[240:243], v252 offset:0
ds_read_b128 v[244:247], v252 offset:4096
s_mov_b64 exec, -1
v_mfma_f32_16x16x32_bf16 v[72:75], v[140:143], v[104:107], 0
v_mul_u32_u24 v208, 4224, v10
v_lshl_add_u32 v208, v12, 3, v208
v_mfma_f32_16x16x32_bf16 v[68:71], v[140:143], v[100:103], 0
v_lshl_add_u32 v208, v11, 4, v208
v_add_u32 v208, s44, v208
v_mfma_f32_16x16x32_bf16 v[64:67], v[140:143], v[96:99], 0
v_mul_u32_u24 v209, 4576, v10
v_lshl_add_u32 v209, v11, 4, v209
s_waitcnt lgkmcnt(9)
v_mfma_f32_16x16x32_bf16 v[16:19], v[144:147], v[112:115], v[16:19]
v_add_u32 v209, s45, v209
v_lshlrev_b32 v13, 6, v12
s_waitcnt lgkmcnt(8)
v_mfma_f32_16x16x32_bf16 v[20:23], v[144:147], v[116:119], v[20:23]
v_sub_u32 v209, v209, v13
v_xor_b32 v211, 1, v10
s_waitcnt lgkmcnt(7)
v_mfma_f32_16x16x32_bf16 v[24:27], v[144:147], v[120:123], v[24:27]
v_lshlrev_b32 v211, 4, v211
v_lshlrev_b32 v213, 1, v12
s_waitcnt lgkmcnt(6)
v_mfma_f32_16x16x32_bf16 v[28:31], v[144:147], v[124:127], v[28:31]
v_lshl_add_u32 v213, v11, 2, v213
s_lshl_b32 s44, s32, 13
s_add_u32 s44, s44, 115712
v_mfma_f32_16x16x32_bf16 v[196:199], v[144:147], v[80:83], 0
v_add_u32 v214, s44, v1
s_add_u32 s44, s43, 115712
v_add_u32 v215, s44, v1
s_waitcnt lgkmcnt(4)
v_mfma_f32_16x16x32_bf16 v[44:47], v[148:151], v[124:127], v[44:47]
v_bfe_u32 v10, v0, 2, 2
v_and_b32 v13, 3, v0
v_mfma_f32_16x16x32_bf16 v[40:43], v[148:151], v[120:123], v[40:43]
v_lshlrev_b32 v10, 8, v10
v_lshl_add_u32 v10, v11, 6, v10
v_mfma_f32_16x16x32_bf16 v[36:39], v[148:151], v[116:119], v[36:39]
v_lshl_add_u32 v216, v13, 4, v10
s_lshl_b32 s44, s33, 5
s_add_u32 s44, s44, s34
s_waitcnt lgkmcnt(0)
s_barrier
v_mfma_f32_16x16x32_bf16 v[32:35], v[148:151], v[112:115], v[32:35]
s_lshl_b32 s44, s44, 13
s_add_u32 s44, s44, s43
ds_read_b64_tr_b16 v[128:129], v4 offset:16384
v_mfma_f32_16x16x32_bf16 v[196:199], v[148:151], v[84:87], v[196:199]
s_add_u32 s44, s44, 3145728
v_add_u32 v216, s44, v216
ds_read_b64_tr_b16 v[130:131], v4 offset:17408
v_mfma_f32_16x16x32_bf16 v[48:51], v[152:155], v[112:115], v[48:51]
s_lshl_b32 s44, s99, 7
s_add_u32 s44, s44, 160704
ds_read_b128 v[96:99], v2 offset:16384
v_mfma_f32_16x16x32_bf16 v[52:55], v[152:155], v[116:119], v[52:55]
v_lshl_add_u32 v226, v11, 3, s44
ds_read_b128 v[100:103], v2 offset:18432
v_mfma_f32_16x16x32_bf16 v[56:59], v[152:155], v[120:123], v[56:59]
s_lshl1_add_u32 s44, s35, s98
s_lshl1_add_u32 s46, s36, s99
ds_read_b128 v[104:107], v2 offset:20480
v_mfma_f32_16x16x32_bf16 v[60:63], v[152:155], v[124:127], v[60:63]
s_mul_i32 s45, s44, 229376
s_lshl_b32 s47, s46, 12
ds_read_b128 v[108:111], v2 offset:22528
v_mfma_f32_16x16x32_bf16 v[196:199], v[152:155], v[88:91], v[196:199]
s_add_u32 s45, s45, s47
s_add_u32 s80, s45, 5242880
ds_read_b64_tr_b16 v[132:133], v5 offset:16384
v_mfma_f32_16x16x32_bf16 v[76:79], v[156:159], v[124:127], v[76:79]
s_add_u32 s81, s80, 114688
s_mul_i32 s45, s46, 37
ds_read_b64_tr_b16 v[134:135], v5 offset:17408
v_mfma_f32_16x16x32_bf16 v[72:75], v[156:159], v[120:123], v[72:75]
s_lshr_b32 s45, s45, 8
s_lshl2_add_u32 s44, s44, s45
ds_read_b64_tr_b16 v[136:137], v6 offset:16384
v_mfma_f32_16x16x32_bf16 v[68:71], v[156:159], v[116:119], v[68:71]
s_add_u32 s44, s44, 128
s_lshl_b32 s95, s44, 8
ds_read_b64_tr_b16 v[138:139], v6 offset:17408
v_mfma_f32_16x16x32_bf16 v[64:67], v[156:159], v[112:115], v[64:67]
s_cmp_lg_u32 s42, 7
s_cselect_b32 s82, 1, 0
v_mov_b32 v12, 0x409d30fc
ds_read_b64_tr_b16 v[140:141], v7 offset:16384
v_mfma_f32_16x16x32_bf16 v[196:199], v[156:159], v[92:95], v[196:199]
v_mov_b32 v13, 0xbeeff558
ds_read_b64_tr_b16 v[142:143], v7 offset:17408
s_waitcnt lgkmcnt(9)
v_mfma_f32_16x16x32_bf16 v[16:19], v[128:131], v[96:99], v[16:19]
ds_read_b64_tr_b16 v[144:145], v204 offset:16384
s_lshl_b32 s44, s98, 9
s_add_u32 s44, s44, 161152
s_waitcnt lgkmcnt(9)
v_mfma_f32_16x16x32_bf16 v[20:23], v[128:131], v[100:103], v[20:23]
ds_read_b64_tr_b16 v[146:147], v204 offset:17408
v_add_u32 v9, s44, v8
s_waitcnt lgkmcnt(9)
v_mfma_f32_16x16x32_bf16 v[24:27], v[128:131], v[104:107], v[24:27]
ds_read_b128 v[112:115], v3 offset:16384
s_lshl_b32 s44, s99, 4
s_lshr_b32 s16, s16, s44
s_waitcnt lgkmcnt(9)
v_mfma_f32_16x16x32_bf16 v[28:31], v[128:131], v[108:111], v[28:31]
ds_read_b128 v[116:119], v3 offset:18432
s_and_b32 s16, s16, 0xffff
v_mov_b32 v10, s16
s_waitcnt lgkmcnt(8)
v_mfma_f32_16x16x32_bf16 v[44:47], v[132:135], v[108:111], v[44:47]
ds_read_b128 v[120:123], v3 offset:20480
v_lshlrev_b32 v10, v211, v10
v_mfma_f32_16x16x32_bf16 v[40:43], v[132:135], v[104:107], v[40:43]
ds_read_b128 v[124:127], v3 offset:22528
s_sub_u32 s46, s98, 1
v_and_b32 v10, s46, v10
v_mfma_f32_16x16x32_bf16 v[36:39], v[132:135], v[100:103], v[36:39]
ds_read_b64_tr_b16 v[148:149], v205 offset:16384
v_cmp_eq_u32 vcc, 14, v213
v_mfma_f32_16x16x32_bf16 v[32:35], v[132:135], v[96:99], v[32:35]
ds_read_b64_tr_b16 v[150:151], v205 offset:17408
v_mov_b32 v211, 0
s_waitcnt lgkmcnt(10)
v_mfma_f32_16x16x32_bf16 v[48:51], v[136:139], v[96:99], v[48:51]
ds_read_b64_tr_b16 v[152:153], v206 offset:16384
s_nop 0
v_cndmask_b32 v210, 0, v10, vcc
v_mfma_f32_16x16x32_bf16 v[52:55], v[136:139], v[100:103], v[52:55]
ds_read_b64_tr_b16 v[154:155], v206 offset:17408
v_cmp_eq_u32 vcc, 12, v213
v_mfma_f32_16x16x32_bf16 v[56:59], v[136:139], v[104:107], v[56:59]
ds_read_b64_tr_b16 v[156:157], v207 offset:16384
v_mov_b32 v213, 0
v_mfma_f32_16x16x32_bf16 v[60:63], v[136:139], v[108:111], v[60:63]
ds_read_b64_tr_b16 v[158:159], v207 offset:17408
s_nop 0
v_cndmask_b32 v212, 0, v10, vcc
s_waitcnt lgkmcnt(12)
v_mfma_f32_16x16x32_bf16 v[76:79], v[140:143], v[108:111], v[76:79]
s_cmp_eq_u32 s92, 1
s_cselect_b64 exec, -1, 0
ds_read_b128 v[240:243], v252 offset:16384
ds_read_b128 v[244:247], v252 offset:20480
s_mov_b64 exec, -1
v_mfma_f32_16x16x32_bf16 v[72:75], v[140:143], v[104:107], v[72:75]
v_mfma_f32_16x16x32_bf16 v[68:71], v[140:143], v[100:103], v[68:71]
v_mfma_f32_16x16x32_bf16 v[64:67], v[140:143], v[96:99], v[64:67]
s_waitcnt lgkmcnt(9)
v_mfma_f32_16x16x32_bf16 v[16:19], v[144:147], v[112:115], v[16:19]
s_waitcnt lgkmcnt(8)
v_mfma_f32_16x16x32_bf16 v[20:23], v[144:147], v[116:119], v[20:23]
s_waitcnt lgkmcnt(7)
v_mfma_f32_16x16x32_bf16 v[24:27], v[144:147], v[120:123], v[24:27]
s_waitcnt lgkmcnt(6)
v_mfma_f32_16x16x32_bf16 v[28:31], v[144:147], v[124:127], v[28:31]
v_mfma_f32_16x16x32_bf16 v[196:199], v[144:147], v[80:83], v[196:199]
s_waitcnt lgkmcnt(4)
v_mfma_f32_16x16x32_bf16 v[44:47], v[148:151], v[124:127], v[44:47]
v_mfma_f32_16x16x32_bf16 v[40:43], v[148:151], v[120:123], v[40:43]
v_mfma_f32_16x16x32_bf16 v[36:39], v[148:151], v[116:119], v[36:39]
s_waitcnt lgkmcnt(0)
s_barrier
v_mfma_f32_16x16x32_bf16 v[32:35], v[148:151], v[112:115], v[32:35]
ds_read_b64_tr_b16 v[128:129], v4 offset:32768
v_mfma_f32_16x16x32_bf16 v[196:199], v[148:151], v[84:87], v[196:199]
ds_read_b64_tr_b16 v[130:131], v4 offset:33792
v_mfma_f32_16x16x32_bf16 v[48:51], v[152:155], v[112:115], v[48:51]
ds_read_b128 v[96:99], v2 offset:32768
v_mfma_f32_16x16x32_bf16 v[52:55], v[152:155], v[116:119], v[52:55]
ds_read_b128 v[100:103], v2 offset:34816
v_mfma_f32_16x16x32_bf16 v[56:59], v[152:155], v[120:123], v[56:59]
ds_read_b128 v[104:107], v2 offset:36864
v_mfma_f32_16x16x32_bf16 v[60:63], v[152:155], v[124:127], v[60:63]
ds_read_b128 v[108:111], v2 offset:38912
v_mfma_f32_16x16x32_bf16 v[196:199], v[152:155], v[88:91], v[196:199]
ds_read_b64_tr_b16 v[132:133], v5 offset:32768
v_mfma_f32_16x16x32_bf16 v[76:79], v[156:159], v[124:127], v[76:79]
ds_read_b64_tr_b16 v[134:135], v5 offset:33792
v_mfma_f32_16x16x32_bf16 v[72:75], v[156:159], v[120:123], v[72:75]
ds_read_b64_tr_b16 v[136:137], v6 offset:32768
v_mfma_f32_16x16x32_bf16 v[68:71], v[156:159], v[116:119], v[68:71]
ds_read_b64_tr_b16 v[138:139], v6 offset:33792
v_mfma_f32_16x16x32_bf16 v[64:67], v[156:159], v[112:115], v[64:67]
ds_read_b64_tr_b16 v[140:141], v7 offset:32768
v_mfma_f32_16x16x32_bf16 v[196:199], v[156:159], v[92:95], v[196:199]
ds_read_b64_tr_b16 v[142:143], v7 offset:33792
s_waitcnt lgkmcnt(9)
v_mfma_f32_16x16x32_bf16 v[16:19], v[128:131], v[96:99], v[16:19]
ds_read_b64_tr_b16 v[144:145], v204 offset:32768
s_waitcnt lgkmcnt(9)
v_mfma_f32_16x16x32_bf16 v[20:23], v[128:131], v[100:103], v[20:23]
ds_read_b64_tr_b16 v[146:147], v204 offset:33792
s_waitcnt lgkmcnt(9)
v_mfma_f32_16x16x32_bf16 v[24:27], v[128:131], v[104:107], v[24:27]
ds_read_b128 v[112:115], v3 offset:32768
s_waitcnt lgkmcnt(9)
v_mfma_f32_16x16x32_bf16 v[28:31], v[128:131], v[108:111], v[28:31]
ds_read_b128 v[116:119], v3 offset:34816
s_waitcnt lgkmcnt(8)
v_mfma_f32_16x16x32_bf16 v[44:47], v[132:135], v[108:111], v[44:47]
ds_read_b128 v[120:123], v3 offset:36864
v_mfma_f32_16x16x32_bf16 v[40:43], v[132:135], v[104:107], v[40:43]
ds_read_b128 v[124:127], v3 offset:38912
v_mfma_f32_16x16x32_bf16 v[36:39], v[132:135], v[100:103], v[36:39]
ds_read_b64_tr_b16 v[148:149], v205 offset:32768
v_mfma_f32_16x16x32_bf16 v[32:35], v[132:135], v[96:99], v[32:35]
ds_read_b64_tr_b16 v[150:151], v205 offset:33792
s_waitcnt lgkmcnt(10)
v_mfma_f32_16x16x32_bf16 v[48:51], v[136:139], v[96:99], v[48:51]
ds_read_b64_tr_b16 v[152:153], v206 offset:32768
v_mfma_f32_16x16x32_bf16 v[52:55], v[136:139], v[100:103], v[52:55]
ds_read_b64_tr_b16 v[154:155], v206 offset:33792
v_mfma_f32_16x16x32_bf16 v[56:59], v[136:139], v[104:107], v[56:59]
ds_read_b64_tr_b16 v[156:157], v207 offset:32768
v_mfma_f32_16x16x32_bf16 v[60:63], v[136:139], v[108:111], v[60:63]
ds_read_b64_tr_b16 v[158:159], v207 offset:33792
s_waitcnt lgkmcnt(12)
v_mfma_f32_16x16x32_bf16 v[76:79], v[140:143], v[108:111], v[76:79]
s_cmp_eq_u32 s92, 2
s_cselect_b64 exec, -1, 0
ds_read_b128 v[240:243], v252 offset:32768
ds_read_b128 v[244:247], v252 offset:36864
s_mov_b64 exec, -1
v_mfma_f32_16x16x32_bf16 v[72:75], v[140:143], v[104:107], v[72:75]
v_mfma_f32_16x16x32_bf16 v[68:71], v[140:143], v[100:103], v[68:71]
v_mfma_f32_16x16x32_bf16 v[64:67], v[140:143], v[96:99], v[64:67]
s_waitcnt lgkmcnt(9)
v_mfma_f32_16x16x32_bf16 v[16:19], v[144:147], v[112:115], v[16:19]
s_waitcnt lgkmcnt(8)
v_mfma_f32_16x16x32_bf16 v[20:23], v[144:147], v[116:119], v[20:23]
s_waitcnt lgkmcnt(7)
v_mfma_f32_16x16x32_bf16 v[24:27], v[144:147], v[120:123], v[24:27]
s_waitcnt lgkmcnt(6)
v_mfma_f32_16x16x32_bf16 v[28:31], v[144:147], v[124:127], v[28:31]
v_mfma_f32_16x16x32_bf16 v[196:199], v[144:147], v[80:83], v[196:199]
s_waitcnt lgkmcnt(4)
v_mfma_f32_16x16x32_bf16 v[44:47], v[148:151], v[124:127], v[44:47]
v_mfma_f32_16x16x32_bf16 v[40:43], v[148:151], v[120:123], v[40:43]
v_mfma_f32_16x16x32_bf16 v[36:39], v[148:151], v[116:119], v[36:39]
s_waitcnt lgkmcnt(0)
s_barrier
v_mfma_f32_16x16x32_bf16 v[32:35], v[148:151], v[112:115], v[32:35]
ds_read_b64_tr_b16 v[128:129], v4 offset:0
v_mfma_f32_16x16x32_bf16 v[196:199], v[148:151], v[84:87], v[196:199]
ds_read_b64_tr_b16 v[130:131], v4 offset:1024
v_mfma_f32_16x16x32_bf16 v[48:51], v[152:155], v[112:115], v[48:51]
ds_read_b128 v[96:99], v2 offset:0
v_mfma_f32_16x16x32_bf16 v[52:55], v[152:155], v[116:119], v[52:55]
ds_read_b128 v[100:103], v2 offset:2048
v_mfma_f32_16x16x32_bf16 v[56:59], v[152:155], v[120:123], v[56:59]
ds_read_b128 v[104:107], v2 offset:4096
v_mfma_f32_16x16x32_bf16 v[60:63], v[152:155], v[124:127], v[60:63]
ds_read_b128 v[108:111], v2 offset:6144
v_mfma_f32_16x16x32_bf16 v[196:199], v[152:155], v[88:91], v[196:199]
ds_read_b64_tr_b16 v[132:133], v5 offset:0
v_mfma_f32_16x16x32_bf16 v[76:79], v[156:159], v[124:127], v[76:79]
ds_read_b64_tr_b16 v[134:135], v5 offset:1024
v_mfma_f32_16x16x32_bf16 v[72:75], v[156:159], v[120:123], v[72:75]
ds_read_b64_tr_b16 v[136:137], v6 offset:0
v_mfma_f32_16x16x32_bf16 v[68:71], v[156:159], v[116:119], v[68:71]
ds_read_b64_tr_b16 v[138:139], v6 offset:1024
v_mfma_f32_16x16x32_bf16 v[64:67], v[156:159], v[112:115], v[64:67]
ds_read_b64_tr_b16 v[140:141], v7 offset:0
v_mfma_f32_16x16x32_bf16 v[196:199], v[156:159], v[92:95], v[196:199]
ds_read_b64_tr_b16 v[142:143], v7 offset:1024
s_waitcnt lgkmcnt(9)
v_mfma_f32_16x16x32_bf16 v[16:19], v[128:131], v[96:99], v[16:19]
ds_read_b64_tr_b16 v[144:145], v204 offset:0
s_waitcnt lgkmcnt(9)
v_mfma_f32_16x16x32_bf16 v[20:23], v[128:131], v[100:103], v[20:23]
ds_read_b64_tr_b16 v[146:147], v204 offset:1024
s_waitcnt lgkmcnt(9)
v_mfma_f32_16x16x32_bf16 v[24:27], v[128:131], v[104:107], v[24:27]
ds_read_b128 v[112:115], v3 offset:0
s_waitcnt lgkmcnt(9)
v_mfma_f32_16x16x32_bf16 v[28:31], v[128:131], v[108:111], v[28:31]
ds_read_b128 v[116:119], v3 offset:2048
s_waitcnt lgkmcnt(8)
v_mfma_f32_16x16x32_bf16 v[44:47], v[132:135], v[108:111], v[44:47]
ds_read_b128 v[120:123], v3 offset:4096
v_mfma_f32_16x16x32_bf16 v[40:43], v[132:135], v[104:107], v[40:43]
ds_read_b128 v[124:127], v3 offset:6144
v_mfma_f32_16x16x32_bf16 v[36:39], v[132:135], v[100:103], v[36:39]
ds_read_b64_tr_b16 v[148:149], v205 offset:0
v_mfma_f32_16x16x32_bf16 v[32:35], v[132:135], v[96:99], v[32:35]
ds_read_b64_tr_b16 v[150:151], v205 offset:1024
s_waitcnt lgkmcnt(10)
v_mfma_f32_16x16x32_bf16 v[48:51], v[136:139], v[96:99], v[48:51]
ds_read_b64_tr_b16 v[152:153], v206 offset:0
v_mfma_f32_16x16x32_bf16 v[52:55], v[136:139], v[100:103], v[52:55]
ds_read_b64_tr_b16 v[154:155], v206 offset:1024
v_mfma_f32_16x16x32_bf16 v[56:59], v[136:139], v[104:107], v[56:59]
ds_read_b64_tr_b16 v[156:157], v207 offset:0
v_mfma_f32_16x16x32_bf16 v[60:63], v[136:139], v[108:111], v[60:63]
ds_read_b64_tr_b16 v[158:159], v207 offset:1024
s_waitcnt lgkmcnt(12)
v_mfma_f32_16x16x32_bf16 v[76:79], v[140:143], v[108:111], v[76:79]
s_cmp_eq_u32 s92, 3
s_cselect_b64 exec, -1, 0
ds_read_b128 v[240:243], v252 offset:0
ds_read_b128 v[244:247], v252 offset:4096
s_mov_b64 exec, -1
v_mfma_f32_16x16x32_bf16 v[72:75], v[140:143], v[104:107], v[72:75]
v_mfma_f32_16x16x32_bf16 v[68:71], v[140:143], v[100:103], v[68:71]
ds_read2_b64 v[188:191], v226 offset0:0 offset1:4
v_mfma_f32_16x16x32_bf16 v[64:67], v[140:143], v[96:99], v[64:67]
ds_read2_b64 v[192:195], v226 offset0:8 offset1:12
s_waitcnt lgkmcnt(11)
v_mfma_f32_16x16x32_bf16 v[16:19], v[144:147], v[112:115], v[16:19]
s_waitcnt lgkmcnt(10)
v_mfma_f32_16x16x32_bf16 v[20:23], v[144:147], v[116:119], v[20:23]
s_waitcnt lgkmcnt(9)
v_mfma_f32_16x16x32_bf16 v[24:27], v[144:147], v[120:123], v[24:27]
s_waitcnt lgkmcnt(8)
v_mfma_f32_16x16x32_bf16 v[28:31], v[144:147], v[124:127], v[28:31]
v_mfma_f32_16x16x32_bf16 v[196:199], v[144:147], v[80:83], v[196:199]
s_waitcnt lgkmcnt(6)
v_mfma_f32_16x16x32_bf16 v[44:47], v[148:151], v[124:127], v[44:47]
v_mfma_f32_16x16x32_bf16 v[40:43], v[148:151], v[120:123], v[40:43]
v_mfma_f32_16x16x32_bf16 v[36:39], v[148:151], v[116:119], v[36:39]
s_waitcnt lgkmcnt(0)
s_barrier
v_mfma_f32_16x16x32_bf16 v[32:35], v[148:151], v[112:115], v[32:35]
ds_read_b64_tr_b16 v[128:129], v4 offset:16384
v_mfma_f32_16x16x32_bf16 v[196:199], v[148:151], v[84:87], v[196:199]
ds_read_b64_tr_b16 v[130:131], v4 offset:17408
v_mfma_f32_16x16x32_bf16 v[48:51], v[152:155], v[112:115], v[48:51]
ds_read_b128 v[96:99], v2 offset:16384
v_mfma_f32_16x16x32_bf16 v[52:55], v[152:155], v[116:119], v[52:55]
ds_read_b128 v[100:103], v2 offset:18432
v_mfma_f32_16x16x32_bf16 v[56:59], v[152:155], v[120:123], v[56:59]
ds_read_b128 v[104:107], v2 offset:20480
v_mfma_f32_16x16x32_bf16 v[60:63], v[152:155], v[124:127], v[60:63]
ds_read_b128 v[108:111], v2 offset:22528
v_mfma_f32_16x16x32_bf16 v[196:199], v[152:155], v[88:91], v[196:199]
ds_read_b64_tr_b16 v[132:133], v5 offset:16384
v_mfma_f32_16x16x32_bf16 v[76:79], v[156:159], v[124:127], v[76:79]
ds_read_b64_tr_b16 v[134:135], v5 offset:17408
v_mfma_f32_16x16x32_bf16 v[72:75], v[156:159], v[120:123], v[72:75]
ds_read_b64_tr_b16 v[136:137], v6 offset:16384
v_mfma_f32_16x16x32_bf16 v[68:71], v[156:159], v[116:119], v[68:71]
ds_read_b64_tr_b16 v[138:139], v6 offset:17408
v_mfma_f32_16x16x32_bf16 v[64:67], v[156:159], v[112:115], v[64:67]
ds_read_b64_tr_b16 v[140:141], v7 offset:16384
v_mfma_f32_16x16x32_bf16 v[196:199], v[156:159], v[92:95], v[196:199]
ds_read_b64_tr_b16 v[142:143], v7 offset:17408
s_waitcnt lgkmcnt(9)
v_mfma_f32_16x16x32_bf16 v[16:19], v[128:131], v[96:99], v[16:19]
ds_read_b64_tr_b16 v[144:145], v204 offset:16384
s_waitcnt lgkmcnt(9)
v_mfma_f32_16x16x32_bf16 v[20:23], v[128:131], v[100:103], v[20:23]
ds_read_b64_tr_b16 v[146:147], v204 offset:17408
s_waitcnt lgkmcnt(9)
v_mfma_f32_16x16x32_bf16 v[24:27], v[128:131], v[104:107], v[24:27]
ds_read_b128 v[112:115], v3 offset:16384
s_waitcnt lgkmcnt(9)
v_mfma_f32_16x16x32_bf16 v[28:31], v[128:131], v[108:111], v[28:31]
ds_read_b128 v[116:119], v3 offset:18432
s_waitcnt lgkmcnt(8)
v_mfma_f32_16x16x32_bf16 v[44:47], v[132:135], v[108:111], v[44:47]
ds_read_b128 v[120:123], v3 offset:20480
v_mfma_f32_16x16x32_bf16 v[40:43], v[132:135], v[104:107], v[40:43]
ds_read_b128 v[124:127], v3 offset:22528
v_mfma_f32_16x16x32_bf16 v[36:39], v[132:135], v[100:103], v[36:39]
ds_read_b64_tr_b16 v[148:149], v205 offset:16384
v_mfma_f32_16x16x32_bf16 v[32:35], v[132:135], v[96:99], v[32:35]
ds_read_b64_tr_b16 v[150:151], v205 offset:17408
s_waitcnt lgkmcnt(10)
v_mfma_f32_16x16x32_bf16 v[48:51], v[136:139], v[96:99], v[48:51]
ds_read_b64_tr_b16 v[152:153], v206 offset:16384
v_mfma_f32_16x16x32_bf16 v[52:55], v[136:139], v[100:103], v[52:55]
ds_read_b64_tr_b16 v[154:155], v206 offset:17408
v_mfma_f32_16x16x32_bf16 v[56:59], v[136:139], v[104:107], v[56:59]
ds_read_b64_tr_b16 v[156:157], v207 offset:16384
v_mfma_f32_16x16x32_bf16 v[60:63], v[136:139], v[108:111], v[60:63]
ds_read_b64_tr_b16 v[158:159], v207 offset:17408
s_waitcnt lgkmcnt(12)
v_mfma_f32_16x16x32_bf16 v[76:79], v[140:143], v[108:111], v[76:79]
s_cmp_eq_u32 s92, 4
s_cselect_b64 exec, -1, 0
ds_read_b128 v[240:243], v252 offset:16384
ds_read_b128 v[244:247], v252 offset:20480
s_mov_b64 exec, -1
v_mfma_f32_16x16x32_bf16 v[72:75], v[140:143], v[104:107], v[72:75]
v_lshlrev_b32 v164, 16, v188
v_and_b32 v165, 0xffff0000, v188
v_mfma_f32_16x16x32_bf16 v[68:71], v[140:143], v[100:103], v[68:71]
v_lshlrev_b32 v166, 16, v189
v_and_b32 v167, 0xffff0000, v189
v_mfma_f32_16x16x32_bf16 v[64:67], v[140:143], v[96:99], v[64:67]
v_lshlrev_b32 v168, 16, v190
v_and_b32 v169, 0xffff0000, v190
s_waitcnt lgkmcnt(9)
v_mfma_f32_16x16x32_bf16 v[16:19], v[144:147], v[112:115], v[16:19]
v_lshlrev_b32 v170, 16, v191
v_and_b32 v171, 0xffff0000, v191
s_waitcnt lgkmcnt(8)
v_mfma_f32_16x16x32_bf16 v[20:23], v[144:147], v[116:119], v[20:23]
v_lshlrev_b32 v172, 16, v192
v_and_b32 v173, 0xffff0000, v192
s_waitcnt lgkmcnt(7)
v_mfma_f32_16x16x32_bf16 v[24:27], v[144:147], v[120:123], v[24:27]
v_lshlrev_b32 v174, 16, v193
v_and_b32 v175, 0xffff0000, v193
s_waitcnt lgkmcnt(6)
v_mfma_f32_16x16x32_bf16 v[28:31], v[144:147], v[124:127], v[28:31]
v_lshlrev_b32 v176, 16, v194
v_and_b32 v177, 0xffff0000, v194
v_mfma_f32_16x16x32_bf16 v[196:199], v[144:147], v[80:83], v[196:199]
v_lshlrev_b32 v178, 16, v195
v_and_b32 v179, 0xffff0000, v195
s_waitcnt lgkmcnt(4)
v_mfma_f32_16x16x32_bf16 v[44:47], v[148:151], v[124:127], v[44:47]
v_mul_f32 v164, v13, v164
v_mul_f32 v165, v13, v165
v_mfma_f32_16x16x32_bf16 v[40:43], v[148:151], v[120:123], v[40:43]
v_mul_f32 v166, v13, v166
v_mul_f32 v167, v13, v167
v_mfma_f32_16x16x32_bf16 v[36:39], v[148:151], v[116:119], v[36:39]
v_mul_f32 v168, v13, v168
v_mul_f32 v169, v13, v169
s_waitcnt lgkmcnt(0)
s_barrier
v_mfma_f32_16x16x32_bf16 v[32:35], v[148:151], v[112:115], v[32:35]
ds_read_b64_tr_b16 v[128:129], v4 offset:32768
v_mfma_f32_16x16x32_bf16 v[196:199], v[148:151], v[84:87], v[196:199]
ds_read_b64_tr_b16 v[130:131], v4 offset:33792
v_mfma_f32_16x16x32_bf16 v[48:51], v[152:155], v[112:115], v[48:51]
ds_read_b128 v[96:99], v2 offset:32768
v_mfma_f32_16x16x32_bf16 v[52:55], v[152:155], v[116:119], v[52:55]
ds_read_b128 v[100:103], v2 offset:34816
v_mfma_f32_16x16x32_bf16 v[56:59], v[152:155], v[120:123], v[56:59]
ds_read_b128 v[104:107], v2 offset:36864
v_mfma_f32_16x16x32_bf16 v[60:63], v[152:155], v[124:127], v[60:63]
ds_read_b128 v[108:111], v2 offset:38912
v_mfma_f32_16x16x32_bf16 v[196:199], v[152:155], v[88:91], v[196:199]
ds_read_b64_tr_b16 v[132:133], v5 offset:32768
v_mfma_f32_16x16x32_bf16 v[76:79], v[156:159], v[124:127], v[76:79]
ds_read_b64_tr_b16 v[134:135], v5 offset:33792
v_mfma_f32_16x16x32_bf16 v[72:75], v[156:159], v[120:123], v[72:75]
ds_read_b64_tr_b16 v[136:137], v6 offset:32768
v_mfma_f32_16x16x32_bf16 v[68:71], v[156:159], v[116:119], v[68:71]
ds_read_b64_tr_b16 v[138:139], v6 offset:33792
v_mfma_f32_16x16x32_bf16 v[64:67], v[156:159], v[112:115], v[64:67]
ds_read_b64_tr_b16 v[140:141], v7 offset:32768
v_mfma_f32_16x16x32_bf16 v[196:199], v[156:159], v[92:95], v[196:199]
ds_read_b64_tr_b16 v[142:143], v7 offset:33792
s_waitcnt lgkmcnt(9)
v_mfma_f32_16x16x32_bf16 v[16:19], v[128:131], v[96:99], v[16:19]
ds_read_b64_tr_b16 v[144:145], v204 offset:32768
s_waitcnt lgkmcnt(9)
v_mfma_f32_16x16x32_bf16 v[20:23], v[128:131], v[100:103], v[20:23]
ds_read_b64_tr_b16 v[146:147], v204 offset:33792
s_waitcnt lgkmcnt(9)
v_mfma_f32_16x16x32_bf16 v[24:27], v[128:131], v[104:107], v[24:27]
ds_read_b128 v[112:115], v3 offset:32768
s_waitcnt lgkmcnt(9)
v_mfma_f32_16x16x32_bf16 v[28:31], v[128:131], v[108:111], v[28:31]
ds_read_b128 v[116:119], v3 offset:34816
s_waitcnt lgkmcnt(8)
v_mfma_f32_16x16x32_bf16 v[44:47], v[132:135], v[108:111], v[44:47]
ds_read_b128 v[120:123], v3 offset:36864
v_mfma_f32_16x16x32_bf16 v[40:43], v[132:135], v[104:107], v[40:43]
ds_read_b128 v[124:127], v3 offset:38912
v_mfma_f32_16x16x32_bf16 v[36:39], v[132:135], v[100:103], v[36:39]
ds_read_b64_tr_b16 v[148:149], v205 offset:32768
v_mfma_f32_16x16x32_bf16 v[32:35], v[132:135], v[96:99], v[32:35]
ds_read_b64_tr_b16 v[150:151], v205 offset:33792
s_waitcnt lgkmcnt(10)
v_mfma_f32_16x16x32_bf16 v[48:51], v[136:139], v[96:99], v[48:51]
ds_read_b64_tr_b16 v[152:153], v206 offset:32768
v_mfma_f32_16x16x32_bf16 v[52:55], v[136:139], v[100:103], v[52:55]
ds_read_b64_tr_b16 v[154:155], v206 offset:33792
v_mfma_f32_16x16x32_bf16 v[56:59], v[136:139], v[104:107], v[56:59]
ds_read_b64_tr_b16 v[156:157], v207 offset:32768
v_mfma_f32_16x16x32_bf16 v[60:63], v[136:139], v[108:111], v[60:63]
ds_read_b64_tr_b16 v[158:159], v207 offset:33792
s_waitcnt lgkmcnt(12)
v_mfma_f32_16x16x32_bf16 v[76:79], v[140:143], v[108:111], v[76:79]
s_cmp_eq_u32 s92, 5
s_cselect_b64 exec, -1, 0
ds_read_b128 v[240:243], v252 offset:32768
ds_read_b128 v[244:247], v252 offset:36864
s_mov_b64 exec, -1
v_mfma_f32_16x16x32_bf16 v[72:75], v[140:143], v[104:107], v[72:75]
v_mul_f32 v170, v13, v170
v_mul_f32 v171, v13, v171
v_mfma_f32_16x16x32_bf16 v[68:71], v[140:143], v[100:103], v[68:71]
v_mul_f32 v172, v13, v172
v_mul_f32 v173, v13, v173
v_mfma_f32_16x16x32_bf16 v[64:67], v[140:143], v[96:99], v[64:67]
v_mul_f32 v174, v13, v174
v_mul_f32 v175, v13, v175
s_waitcnt lgkmcnt(9)
v_mfma_f32_16x16x32_bf16 v[16:19], v[144:147], v[112:115], v[16:19]
v_mul_f32 v176, v13, v176
v_mul_f32 v177, v13, v177
s_waitcnt lgkmcnt(8)
v_mfma_f32_16x16x32_bf16 v[20:23], v[144:147], v[116:119], v[20:23]
v_mul_f32 v178, v13, v178
v_mul_f32 v179, v13, v179
s_waitcnt lgkmcnt(7)
v_mfma_f32_16x16x32_bf16 v[24:27], v[144:147], v[120:123], v[24:27]
s_waitcnt lgkmcnt(6)
v_mfma_f32_16x16x32_bf16 v[28:31], v[144:147], v[124:127], v[28:31]
v_mfma_f32_16x16x32_bf16 v[196:199], v[144:147], v[80:83], v[196:199]
s_waitcnt lgkmcnt(4)
v_mfma_f32_16x16x32_bf16 v[44:47], v[148:151], v[124:127], v[44:47]
v_mfma_f32_16x16x32_bf16 v[40:43], v[148:151], v[120:123], v[40:43]
v_mfma_f32_16x16x32_bf16 v[36:39], v[148:151], v[116:119], v[36:39]
s_waitcnt lgkmcnt(0)
s_barrier
v_mfma_f32_16x16x32_bf16 v[32:35], v[148:151], v[112:115], v[32:35]
ds_read_b64_tr_b16 v[128:129], v4 offset:0
v_mfma_f32_16x16x32_bf16 v[196:199], v[148:151], v[84:87], v[196:199]
ds_read_b64_tr_b16 v[130:131], v4 offset:1024
v_mfma_f32_16x16x32_bf16 v[48:51], v[152:155], v[112:115], v[48:51]
ds_read_b128 v[96:99], v2 offset:0
v_mfma_f32_16x16x32_bf16 v[52:55], v[152:155], v[116:119], v[52:55]
ds_read_b128 v[100:103], v2 offset:2048
v_mfma_f32_16x16x32_bf16 v[56:59], v[152:155], v[120:123], v[56:59]
ds_read_b128 v[104:107], v2 offset:4096
v_mfma_f32_16x16x32_bf16 v[60:63], v[152:155], v[124:127], v[60:63]
ds_read_b128 v[108:111], v2 offset:6144
v_mfma_f32_16x16x32_bf16 v[196:199], v[152:155], v[88:91], v[196:199]
ds_read_b64_tr_b16 v[132:133], v5 offset:0
v_mfma_f32_16x16x32_bf16 v[76:79], v[156:159], v[124:127], v[76:79]
ds_read_b64_tr_b16 v[134:135], v5 offset:1024
v_mfma_f32_16x16x32_bf16 v[72:75], v[156:159], v[120:123], v[72:75]
ds_read_b64_tr_b16 v[136:137], v6 offset:0
v_mfma_f32_16x16x32_bf16 v[68:71], v[156:159], v[116:119], v[68:71]
ds_read_b64_tr_b16 v[138:139], v6 offset:1024
v_mfma_f32_16x16x32_bf16 v[64:67], v[156:159], v[112:115], v[64:67]
ds_read_b64_tr_b16 v[140:141], v7 offset:0
v_mfma_f32_16x16x32_bf16 v[196:199], v[156:159], v[92:95], v[196:199]
ds_read_b64_tr_b16 v[142:143], v7 offset:1024
s_waitcnt lgkmcnt(9)
v_mfma_f32_16x16x32_bf16 v[16:19], v[128:131], v[96:99], v[16:19]
ds_read_b64_tr_b16 v[144:145], v204 offset:0
s_waitcnt lgkmcnt(9)
v_mfma_f32_16x16x32_bf16 v[20:23], v[128:131], v[100:103], v[20:23]
ds_read_b64_tr_b16 v[146:147], v204 offset:1024
s_waitcnt lgkmcnt(9)
v_mfma_f32_16x16x32_bf16 v[24:27], v[128:131], v[104:107], v[24:27]
ds_read_b128 v[112:115], v3 offset:0
s_waitcnt lgkmcnt(9)
v_mfma_f32_16x16x32_bf16 v[28:31], v[128:131], v[108:111], v[28:31]
ds_read_b128 v[116:119], v3 offset:2048
v_mfma_f32_16x16x32_bf16 v[160:163], v[128:131], v[80:83], 0
s_mov_b32 s44, 0xaaaaaaaa
s_mov_b32 s45, s44
ds_read_b128 v[120:123], v3 offset:4096
s_waitcnt lgkmcnt(9)
v_mfma_f32_16x16x32_bf16 v[44:47], v[132:135], v[108:111], v[44:47]
s_mov_b32 s46, 0xcccccccc
s_mov_b32 s47, s46
ds_read_b128 v[124:127], v3 offset:6144
v_mfma_f32_16x16x32_bf16 v[40:43], v[132:135], v[104:107], v[40:43]
ds_read_b64_tr_b16 v[148:149], v205 offset:0
v_mfma_f32_16x16x32_bf16 v[36:39], v[132:135], v[100:103], v[36:39]
ds_read_b64_tr_b16 v[150:151], v205 offset:1024
v_mfma_f32_16x16x32_bf16 v[32:35], v[132:135], v[96:99], v[32:35]
ds_read_b64_tr_b16 v[152:153], v206 offset:0
v_mfma_f32_16x16x32_bf16 v[160:163], v[132:135], v[84:87], v[160:163]
ds_read_b64_tr_b16 v[154:155], v206 offset:1024
s_waitcnt lgkmcnt(12)
v_mfma_f32_16x16x32_bf16 v[48:51], v[136:139], v[96:99], v[48:51]
ds_read_b64_tr_b16 v[156:157], v207 offset:0
v_mfma_f32_16x16x32_bf16 v[52:55], v[136:139], v[100:103], v[52:55]
ds_read_b64_tr_b16 v[158:159], v207 offset:1024
v_mfma_f32_16x16x32_bf16 v[56:59], v[136:139], v[104:107], v[56:59]
s_cmp_eq_u32 s92, 6
s_cselect_b64 exec, -1, 0
ds_read_b128 v[240:243], v252 offset:0
ds_read_b128 v[244:247], v252 offset:4096
s_mov_b64 exec, -1
v_mfma_f32_16x16x32_bf16 v[60:63], v[136:139], v[108:111], v[60:63]
v_cndmask_b32 v10, v196, v197, s[44:45]
v_cndmask_b32 v11, v198, v199, s[44:45]
v_mfma_f32_16x16x32_bf16 v[160:163], v[136:139], v[88:91], v[160:163]
v_cndmask_b32 v10, v10, v11, s[46:47]
s_waitcnt lgkmcnt(12)
v_mfma_f32_16x16x32_bf16 v[76:79], v[140:143], v[108:111], v[76:79]
ds_write_b32 v14, v10
v_mfma_f32_16x16x32_bf16 v[72:75], v[140:143], v[104:107], v[72:75]
v_mfma_f32_16x16x32_bf16 v[68:71], v[140:143], v[100:103], v[68:71]
v_mfma_f32_16x16x32_bf16 v[64:67], v[140:143], v[96:99], v[64:67]
v_mfma_f32_16x16x32_bf16 v[160:163], v[140:143], v[92:95], v[160:163]
s_waitcnt lgkmcnt(10)
v_mfma_f32_16x16x32_bf16 v[16:19], v[144:147], v[112:115], v[16:19]
s_waitcnt lgkmcnt(9)
v_mfma_f32_16x16x32_bf16 v[20:23], v[144:147], v[116:119], v[20:23]
s_waitcnt lgkmcnt(8)
v_mfma_f32_16x16x32_bf16 v[24:27], v[144:147], v[120:123], v[24:27]
s_waitcnt lgkmcnt(7)
v_mfma_f32_16x16x32_bf16 v[28:31], v[144:147], v[124:127], v[28:31]
v_mfma_f32_16x16x32_bf16 v[160:163], v[144:147], v[80:83], v[160:163]
s_waitcnt lgkmcnt(5)
v_mfma_f32_16x16x32_bf16 v[44:47], v[148:151], v[124:127], v[44:47]
v_mfma_f32_16x16x32_bf16 v[40:43], v[148:151], v[120:123], v[40:43]
v_mfma_f32_16x16x32_bf16 v[36:39], v[148:151], v[116:119], v[36:39]
v_mfma_f32_16x16x32_bf16 v[32:35], v[148:151], v[112:115], v[32:35]
v_mfma_f32_16x16x32_bf16 v[160:163], v[148:151], v[84:87], v[160:163]
s_waitcnt lgkmcnt(3)
v_mfma_f32_16x16x32_bf16 v[48:51], v[152:155], v[112:115], v[48:51]
s_waitcnt lgkmcnt(0)
s_barrier
ds_read_b64_tr_b16 v[128:129], v4 offset:16384
ds_read_b64_tr_b16 v[130:131], v4 offset:17408
ds_read_b128 v[96:99], v2 offset:16384
v_mfma_f32_16x16x32_bf16 v[52:55], v[152:155], v[116:119], v[52:55]
ds_read_b128 v[100:103], v2 offset:18432
v_mfma_f32_16x16x32_bf16 v[56:59], v[152:155], v[120:123], v[56:59]
ds_read_b128 v[104:107], v2 offset:20480
v_mfma_f32_16x16x32_bf16 v[60:63], v[152:155], v[124:127], v[60:63]
ds_read_b128 v[108:111], v2 offset:22528
v_mfma_f32_16x16x32_bf16 v[160:163], v[152:155], v[88:91], v[160:163]
ds_read_b64_tr_b16 v[132:133], v5 offset:16384
v_mfma_f32_16x16x32_bf16 v[76:79], v[156:159], v[124:127], v[76:79]
ds_read_b64_tr_b16 v[134:135], v5 offset:17408
v_mfma_f32_16x16x32_bf16 v[72:75], v[156:159], v[120:123], v[72:75]
ds_read_b64_tr_b16 v[136:137], v6 offset:16384
v_mfma_f32_16x16x32_bf16 v[68:71], v[156:159], v[116:119], v[68:71]
ds_read_b64_tr_b16 v[138:139], v6 offset:17408
v_mfma_f32_16x16x32_bf16 v[64:67], v[156:159], v[112:115], v[64:67]
ds_read_b64_tr_b16 v[140:141], v7 offset:16384
v_mfma_f32_16x16x32_bf16 v[160:163], v[156:159], v[92:95], v[160:163]
ds_read_b64_tr_b16 v[142:143], v7 offset:17408
s_waitcnt lgkmcnt(9)
v_mfma_f32_16x16x32_bf16 v[16:19], v[128:131], v[96:99], v[16:19]
ds_read_b64_tr_b16 v[144:145], v204 offset:16384
s_waitcnt lgkmcnt(9)
v_mfma_f32_16x16x32_bf16 v[20:23], v[128:131], v[100:103], v[20:23]
ds_read_b64_tr_b16 v[146:147], v204 offset:17408
s_waitcnt lgkmcnt(9)
v_mfma_f32_16x16x32_bf16 v[24:27], v[128:131], v[104:107], v[24:27]
ds_read_b128 v[112:115], v3 offset:16384
s_waitcnt lgkmcnt(9)
v_mfma_f32_16x16x32_bf16 v[28:31], v[128:131], v[108:111], v[28:31]
ds_read_b128 v[116:119], v3 offset:18432
v_mfma_f32_16x16x32_bf16 v[160:163], v[128:131], v[80:83], v[160:163]
ds_read_b128 v[120:123], v3 offset:20480
s_waitcnt lgkmcnt(9)
v_mfma_f32_16x16x32_bf16 v[44:47], v[132:135], v[108:111], v[44:47]
ds_read_b128 v[124:127], v3 offset:22528
v_mfma_f32_16x16x32_bf16 v[40:43], v[132:135], v[104:107], v[40:43]
ds_read_b64_tr_b16 v[148:149], v205 offset:16384
v_mfma_f32_16x16x32_bf16 v[36:39], v[132:135], v[100:103], v[36:39]
ds_read_b64_tr_b16 v[150:151], v205 offset:17408
v_mfma_f32_16x16x32_bf16 v[32:35], v[132:135], v[96:99], v[32:35]
ds_read_b64_tr_b16 v[152:153], v206 offset:16384
v_mfma_f32_16x16x32_bf16 v[160:163], v[132:135], v[84:87], v[160:163]
ds_read_b64_tr_b16 v[154:155], v206 offset:17408
s_waitcnt lgkmcnt(12)
v_mfma_f32_16x16x32_bf16 v[48:51], v[136:139], v[96:99], v[48:51]
ds_read_b64_tr_b16 v[156:157], v207 offset:16384
v_mfma_f32_16x16x32_bf16 v[52:55], v[136:139], v[100:103], v[52:55]
ds_read_b64_tr_b16 v[158:159], v207 offset:17408
v_mfma_f32_16x16x32_bf16 v[56:59], v[136:139], v[104:107], v[56:59]
s_cmp_eq_u32 s92, 7
s_cselect_b64 exec, -1, 0
ds_read_b128 v[240:243], v252 offset:16384
ds_read_b128 v[244:247], v252 offset:20480
s_mov_b64 exec, -1
v_mfma_f32_16x16x32_bf16 v[60:63], v[136:139], v[108:111], v[60:63]
v_mfma_f32_16x16x32_bf16 v[160:163], v[136:139], v[88:91], v[160:163]
s_waitcnt lgkmcnt(13)
ds_read2_b64 v[180:183], v9 offset0:0 offset1:16
s_waitcnt lgkmcnt(13)
v_mfma_f32_16x16x32_bf16 v[76:79], v[140:143], v[108:111], v[76:79]
ds_read2_b64 v[184:187], v9 offset0:32 offset1:48
v_mfma_f32_16x16x32_bf16 v[72:75], v[140:143], v[104:107], v[72:75]
s_waitcnt lgkmcnt(13)
ds_read_b128 v[200:203], v15
v_mfma_f32_16x16x32_bf16 v[68:71], v[140:143], v[100:103], v[68:71]
v_mfma_f32_16x16x32_bf16 v[64:67], v[140:143], v[96:99], v[64:67]
v_mfma_f32_16x16x32_bf16 v[160:163], v[140:143], v[92:95], v[160:163]
s_waitcnt lgkmcnt(13)
v_mfma_f32_16x16x32_bf16 v[160:163], v[144:147], v[80:83], v[160:163]
s_waitcnt lgkmcnt(0)
v_min3_u32 v10, v180, v181, v182
v_min3_u32 v11, v183, v184, v185
v_mfma_f32_16x16x32_bf16 v[160:163], v[148:151], v[84:87], v[160:163]
v_min3_u32 v10, v10, v186, v187
v_min_u32 v10, v10, v11
v_mfma_f32_16x16x32_bf16 v[160:163], v[152:155], v[88:91], v[160:163]
v_cmp_eq_u32 vcc, 0, v10
s_mov_b32 s94, 0
s_cbranch_vccnz Lst_1003
Lstb_1004:
v_mfma_f32_16x16x32_bf16 v[160:163], v[156:159], v[92:95], v[160:163]
v_mul_f32 v181, v13, v181
v_mul_f32 v183, v13, v183
v_mfma_f32_16x16x32_bf16 v[16:19], v[144:147], v[112:115], v[16:19]
v_mul_f32 v185, v13, v185
v_mul_f32 v187, v13, v187
v_mfma_f32_16x16x32_bf16 v[20:23], v[144:147], v[116:119], v[20:23]
v_mul_f32 v180, v180, v181
v_mul_f32 v182, v182, v183
v_mfma_f32_16x16x32_bf16 v[24:27], v[144:147], v[120:123], v[24:27]
v_mul_f32 v184, v184, v185
v_mul_f32 v186, v186, v187
v_mfma_f32_16x16x32_bf16 v[28:31], v[144:147], v[124:127], v[28:31]
v_add_f32 v196, v196, v200
v_add_f32 v197, v197, v201
v_mfma_f32_16x16x32_bf16 v[44:47], v[148:151], v[124:127], v[44:47]
v_mov_b32 v248, 1
s_mov_b64 exec, 1
ds_add_u32 v227, v248 offset:16
s_mov_b64 exec, -1
v_add_f32 v198, v198, v202
v_add_f32 v199, v199, v203
v_mfma_f32_16x16x32_bf16 v[40:43], v[148:151], v[120:123], v[40:43]
v_add_f32 v160, v160, v196
v_add_f32 v161, v161, v197
v_mfma_f32_16x16x32_bf16 v[36:39], v[148:151], v[116:119], v[36:39]
v_add_f32 v162, v162, v198
v_add_f32 v163, v163, v199
v_mfma_f32_16x16x32_bf16 v[32:35], v[148:151], v[112:115], v[32:35]
v_mfma_f32_16x16x32_bf16 v[48:51], v[152:155], v[112:115], v[48:51]
v_mov_b32_dpp v80, v160 row_newbcast:0 row_mask:0xf bank_mask:0xf
v_mov_b32_dpp v81, v161 row_newbcast:0 row_mask:0xf bank_mask:0xf
v_mfma_f32_16x16x32_bf16 v[52:55], v[152:155], v[116:119], v[52:55]
v_mov_b32_dpp v82, v162 row_newbcast:0 row_mask:0xf bank_mask:0xf
v_mov_b32_dpp v83, v163 row_newbcast:0 row_mask:0xf bank_mask:0xf
v_mfma_f32_16x16x32_bf16 v[56:59], v[152:155], v[120:123], v[56:59]
v_mov_b32_dpp v84, v160 row_newbcast:4 row_mask:0xf bank_mask:0xf
v_mov_b32_dpp v85, v161 row_newbcast:4 row_mask:0xf bank_mask:0xf
v_mfma_f32_16x16x32_bf16 v[60:63], v[152:155], v[124:127], v[60:63]
v_mov_b32_dpp v86, v162 row_newbcast:4 row_mask:0xf bank_mask:0xf
v_mov_b32_dpp v87, v163 row_newbcast:4 row_mask:0xf bank_mask:0xf
v_mfma_f32_16x16x32_bf16 v[76:79], v[156:159], v[124:127], v[76:79]
v_mov_b32_dpp v88, v160 row_newbcast:8 row_mask:0xf bank_mask:0xf
v_mov_b32_dpp v89, v161 row_newbcast:8 row_mask:0xf bank_mask:0xf
v_mfma_f32_16x16x32_bf16 v[72:75], v[156:159], v[120:123], v[72:75]
v_mov_b32_dpp v90, v162 row_newbcast:8 row_mask:0xf bank_mask:0xf
v_mov_b32_dpp v91, v163 row_newbcast:8 row_mask:0xf bank_mask:0xf
v_mfma_f32_16x16x32_bf16 v[68:71], v[156:159], v[116:119], v[68:71]
v_mov_b32_dpp v92, v160 row_newbcast:12 row_mask:0xf bank_mask:0xf
v_mov_b32_dpp v93, v161 row_newbcast:12 row_mask:0xf bank_mask:0xf
v_mfma_f32_16x16x32_bf16 v[64:67], v[156:159], v[112:115], v[64:67]
v_mov_b32_dpp v94, v162 row_newbcast:12 row_mask:0xf bank_mask:0xf
v_mov_b32_dpp v95, v163 row_newbcast:12 row_mask:0xf bank_mask:0xf
s_setprio 2
.p2align 3
v_pk_fma_f32 v[188:189], v[80:81], v[180:181], v[164:165] op_sel_hi:[1,0,1] neg_lo:[0,1,0] neg_hi:[0,1,0]
v_pk_fma_f32 v[190:191], v[82:83], v[180:181], v[166:167] op_sel_hi:[1,0,1] neg_lo:[0,1,0] neg_hi:[0,1,0]
v_pk_fma_f32 v[192:193], v[84:85], v[180:181], v[168:169] op_sel_hi:[1,0,1] neg_lo:[0,1,0] neg_hi:[0,1,0]
v_pk_fma_f32 v[194:195], v[86:87], v[180:181], v[170:171] op_sel_hi:[1,0,1] neg_lo:[0,1,0] neg_hi:[0,1,0]
v_pk_fma_f32 v[16:17], v[180:181], v[16:17], v[188:189] op_sel:[1,0,0]
v_pk_fma_f32 v[18:19], v[180:181], v[18:19], v[190:191] op_sel:[1,0,0]
v_pk_fma_f32 v[32:33], v[180:181], v[32:33], v[192:193] op_sel:[1,0,0]
v_pk_fma_f32 v[34:35], v[180:181], v[34:35], v[194:195] op_sel:[1,0,0]
v_pk_fma_f32 v[188:189], v[16:17], v[16:17], v[12:13] op_sel_hi:[1,1,0]
v_pk_fma_f32 v[190:191], v[18:19], v[18:19], v[12:13] op_sel_hi:[1,1,0]
v_pk_fma_f32 v[192:193], v[32:33], v[32:33], v[12:13] op_sel_hi:[1,1,0]
v_pk_fma_f32 v[194:195], v[34:35], v[34:35], v[12:13] op_sel_hi:[1,1,0]
v_pk_mul_f32 v[188:189], v[188:189], v[16:17]
v_pk_mul_f32 v[190:191], v[190:191], v[18:19]
v_pk_mul_f32 v[192:193], v[192:193], v[32:33]
v_pk_mul_f32 v[194:195], v[194:195], v[34:35]
v_exp_f32 v188, v188
v_exp_f32 v189, v189
v_exp_f32 v190, v190
v_exp_f32 v191, v191
v_exp_f32 v192, v192
v_exp_f32 v193, v193
v_exp_f32 v194, v194
v_exp_f32 v195, v195
v_pk_fma_f32 v[188:189], v[12:13], v[188:189], v[12:13] op_sel:[1,0,1]
v_pk_fma_f32 v[190:191], v[12:13], v[190:191], v[12:13] op_sel:[1,0,1]
v_pk_fma_f32 v[192:193], v[12:13], v[192:193], v[12:13] op_sel:[1,0,1]
v_pk_fma_f32 v[194:195], v[12:13], v[194:195], v[12:13] op_sel:[1,0,1]
v_rcp_f32 v188, v188
v_rcp_f32 v189, v189
v_rcp_f32 v190, v190
v_rcp_f32 v191, v191
v_rcp_f32 v192, v192
v_rcp_f32 v193, v193
v_rcp_f32 v194, v194
v_rcp_f32 v195, v195
v_pk_mul_f32 v[16:17], v[16:17], v[188:189]
v_pk_mul_f32 v[18:19], v[18:19], v[190:191]
v_pk_mul_f32 v[32:33], v[32:33], v[192:193]
v_pk_mul_f32 v[34:35], v[34:35], v[194:195]
v_cvt_pk_bf16_f32 v228, v16, v17
v_cvt_pk_bf16_f32 v229, v18, v19
v_cvt_pk_bf16_f32 v230, v32, v33
v_cvt_pk_bf16_f32 v231, v34, v35
buffer_store_dwordx4 v[228:231], v1, s[64:67], s80 offen offset:0 sc1
v_pk_fma_f32 v[196:197], v[80:81], v[182:183], v[164:165] op_sel_hi:[1,0,1] neg_lo:[0,1,0] neg_hi:[0,1,0]
v_pk_fma_f32 v[198:199], v[82:83], v[182:183], v[166:167] op_sel_hi:[1,0,1] neg_lo:[0,1,0] neg_hi:[0,1,0]
v_pk_fma_f32 v[200:201], v[84:85], v[182:183], v[168:169] op_sel_hi:[1,0,1] neg_lo:[0,1,0] neg_hi:[0,1,0]
v_pk_fma_f32 v[202:203], v[86:87], v[182:183], v[170:171] op_sel_hi:[1,0,1] neg_lo:[0,1,0] neg_hi:[0,1,0]
v_pk_fma_f32 v[20:21], v[182:183], v[20:21], v[196:197] op_sel:[1,0,0]
v_pk_fma_f32 v[22:23], v[182:183], v[22:23], v[198:199] op_sel:[1,0,0]
v_pk_fma_f32 v[36:37], v[182:183], v[36:37], v[200:201] op_sel:[1,0,0]
v_pk_fma_f32 v[38:39], v[182:183], v[38:39], v[202:203] op_sel:[1,0,0]
v_pk_fma_f32 v[196:197], v[20:21], v[20:21], v[12:13] op_sel_hi:[1,1,0]
v_pk_fma_f32 v[198:199], v[22:23], v[22:23], v[12:13] op_sel_hi:[1,1,0]
v_pk_fma_f32 v[200:201], v[36:37], v[36:37], v[12:13] op_sel_hi:[1,1,0]
v_pk_fma_f32 v[202:203], v[38:39], v[38:39], v[12:13] op_sel_hi:[1,1,0]
v_pk_mul_f32 v[196:197], v[196:197], v[20:21]
v_pk_mul_f32 v[198:199], v[198:199], v[22:23]
v_pk_mul_f32 v[200:201], v[200:201], v[36:37]
v_pk_mul_f32 v[202:203], v[202:203], v[38:39]
v_exp_f32 v196, v196
v_exp_f32 v197, v197
v_exp_f32 v198, v198
v_exp_f32 v199, v199
v_exp_f32 v200, v200
v_exp_f32 v201, v201
v_exp_f32 v202, v202
v_exp_f32 v203, v203
v_pk_fma_f32 v[196:197], v[12:13], v[196:197], v[12:13] op_sel:[1,0,1]
v_pk_fma_f32 v[198:199], v[12:13], v[198:199], v[12:13] op_sel:[1,0,1]
v_pk_fma_f32 v[200:201], v[12:13], v[200:201], v[12:13] op_sel:[1,0,1]
v_pk_fma_f32 v[202:203], v[12:13], v[202:203], v[12:13] op_sel:[1,0,1]
v_rcp_f32 v196, v196
v_rcp_f32 v197, v197
v_rcp_f32 v198, v198
v_rcp_f32 v199, v199
v_rcp_f32 v200, v200
v_rcp_f32 v201, v201
v_rcp_f32 v202, v202
v_rcp_f32 v203, v203
v_pk_mul_f32 v[20:21], v[20:21], v[196:197]
v_pk_mul_f32 v[22:23], v[22:23], v[198:199]
v_pk_mul_f32 v[36:37], v[36:37], v[200:201]
v_pk_mul_f32 v[38:39], v[38:39], v[202:203]
v_cvt_pk_bf16_f32 v232, v20, v21
v_cvt_pk_bf16_f32 v233, v22, v23
v_cvt_pk_bf16_f32 v234, v36, v37
v_cvt_pk_bf16_f32 v235, v38, v39
buffer_store_dwordx4 v[232:235], v1, s[64:67], s80 offen offset:1024 sc1
v_pk_fma_f32 v[188:189], v[80:81], v[184:185], v[164:165] op_sel_hi:[1,0,1] neg_lo:[0,1,0] neg_hi:[0,1,0]
v_pk_fma_f32 v[190:191], v[82:83], v[184:185], v[166:167] op_sel_hi:[1,0,1] neg_lo:[0,1,0] neg_hi:[0,1,0]
v_pk_fma_f32 v[192:193], v[84:85], v[184:185], v[168:169] op_sel_hi:[1,0,1] neg_lo:[0,1,0] neg_hi:[0,1,0]
v_pk_fma_f32 v[194:195], v[86:87], v[184:185], v[170:171] op_sel_hi:[1,0,1] neg_lo:[0,1,0] neg_hi:[0,1,0]
v_pk_fma_f32 v[24:25], v[184:185], v[24:25], v[188:189] op_sel:[1,0,0]
v_pk_fma_f32 v[26:27], v[184:185], v[26:27], v[190:191] op_sel:[1,0,0]
v_pk_fma_f32 v[40:41], v[184:185], v[40:41], v[192:193] op_sel:[1,0,0]
v_pk_fma_f32 v[42:43], v[184:185], v[42:43], v[194:195] op_sel:[1,0,0]
v_pk_fma_f32 v[188:189], v[24:25], v[24:25], v[12:13] op_sel_hi:[1,1,0]
v_pk_fma_f32 v[190:191], v[26:27], v[26:27], v[12:13] op_sel_hi:[1,1,0]
v_pk_fma_f32 v[192:193], v[40:41], v[40:41], v[12:13] op_sel_hi:[1,1,0]
v_pk_fma_f32 v[194:195], v[42:43], v[42:43], v[12:13] op_sel_hi:[1,1,0]
v_pk_mul_f32 v[188:189], v[188:189], v[24:25]
v_pk_mul_f32 v[190:191], v[190:191], v[26:27]
v_pk_mul_f32 v[192:193], v[192:193], v[40:41]
v_pk_mul_f32 v[194:195], v[194:195], v[42:43]
v_exp_f32 v188, v188
v_exp_f32 v189, v189
v_exp_f32 v190, v190
v_exp_f32 v191, v191
v_exp_f32 v192, v192
v_exp_f32 v193, v193
v_exp_f32 v194, v194
v_exp_f32 v195, v195
v_pk_fma_f32 v[188:189], v[12:13], v[188:189], v[12:13] op_sel:[1,0,1]
v_pk_fma_f32 v[190:191], v[12:13], v[190:191], v[12:13] op_sel:[1,0,1]
v_pk_fma_f32 v[192:193], v[12:13], v[192:193], v[12:13] op_sel:[1,0,1]
v_pk_fma_f32 v[194:195], v[12:13], v[194:195], v[12:13] op_sel:[1,0,1]
v_rcp_f32 v188, v188
v_rcp_f32 v189, v189
v_rcp_f32 v190, v190
v_rcp_f32 v191, v191
v_rcp_f32 v192, v192
v_rcp_f32 v193, v193
v_rcp_f32 v194, v194
v_rcp_f32 v195, v195
v_pk_mul_f32 v[24:25], v[24:25], v[188:189]
v_pk_mul_f32 v[26:27], v[26:27], v[190:191]
v_pk_mul_f32 v[40:41], v[40:41], v[192:193]
v_pk_mul_f32 v[42:43], v[42:43], v[194:195]
v_cvt_pk_bf16_f32 v228, v24, v25
v_cvt_pk_bf16_f32 v229, v26, v27
v_cvt_pk_bf16_f32 v230, v40, v41
v_cvt_pk_bf16_f32 v231, v42, v43
buffer_store_dwordx4 v[228:231], v1, s[64:67], s80 offen offset:2048 sc1
v_pk_fma_f32 v[196:197], v[80:81], v[186:187], v[164:165] op_sel_hi:[1,0,1] neg_lo:[0,1,0] neg_hi:[0,1,0]
v_pk_fma_f32 v[198:199], v[82:83], v[186:187], v[166:167] op_sel_hi:[1,0,1] neg_lo:[0,1,0] neg_hi:[0,1,0]
v_pk_fma_f32 v[200:201], v[84:85], v[186:187], v[168:169] op_sel_hi:[1,0,1] neg_lo:[0,1,0] neg_hi:[0,1,0]
v_pk_fma_f32 v[202:203], v[86:87], v[186:187], v[170:171] op_sel_hi:[1,0,1] neg_lo:[0,1,0] neg_hi:[0,1,0]
v_pk_fma_f32 v[28:29], v[186:187], v[28:29], v[196:197] op_sel:[1,0,0]
v_pk_fma_f32 v[30:31], v[186:187], v[30:31], v[198:199] op_sel:[1,0,0]
v_pk_fma_f32 v[44:45], v[186:187], v[44:45], v[200:201] op_sel:[1,0,0]
v_pk_fma_f32 v[46:47], v[186:187], v[46:47], v[202:203] op_sel:[1,0,0]
v_pk_fma_f32 v[196:197], v[28:29], v[28:29], v[12:13] op_sel_hi:[1,1,0]
v_pk_fma_f32 v[198:199], v[30:31], v[30:31], v[12:13] op_sel_hi:[1,1,0]
v_pk_fma_f32 v[200:201], v[44:45], v[44:45], v[12:13] op_sel_hi:[1,1,0]
v_pk_fma_f32 v[202:203], v[46:47], v[46:47], v[12:13] op_sel_hi:[1,1,0]
v_pk_mul_f32 v[196:197], v[196:197], v[28:29]
v_pk_mul_f32 v[198:199], v[198:199], v[30:31]
v_pk_mul_f32 v[200:201], v[200:201], v[44:45]
v_pk_mul_f32 v[202:203], v[202:203], v[46:47]
v_exp_f32 v196, v196
v_exp_f32 v197, v197
v_exp_f32 v198, v198
v_exp_f32 v199, v199
v_exp_f32 v200, v200
v_exp_f32 v201, v201
v_exp_f32 v202, v202
v_exp_f32 v203, v203
v_pk_fma_f32 v[196:197], v[12:13], v[196:197], v[12:13] op_sel:[1,0,1]
v_pk_fma_f32 v[198:199], v[12:13], v[198:199], v[12:13] op_sel:[1,0,1]
v_pk_fma_f32 v[200:201], v[12:13], v[200:201], v[12:13] op_sel:[1,0,1]
v_pk_fma_f32 v[202:203], v[12:13], v[202:203], v[12:13] op_sel:[1,0,1]
v_rcp_f32 v196, v196
v_rcp_f32 v197, v197
v_rcp_f32 v198, v198
v_rcp_f32 v199, v199
v_rcp_f32 v200, v200
v_rcp_f32 v201, v201
v_rcp_f32 v202, v202
v_rcp_f32 v203, v203
v_pk_mul_f32 v[28:29], v[28:29], v[196:197]
v_pk_mul_f32 v[30:31], v[30:31], v[198:199]
v_pk_mul_f32 v[44:45], v[44:45], v[200:201]
v_pk_mul_f32 v[46:47], v[46:47], v[202:203]
v_cvt_pk_bf16_f32 v232, v28, v29
v_cvt_pk_bf16_f32 v233, v30, v31
v_cvt_pk_bf16_f32 v234, v44, v45
v_cvt_pk_bf16_f32 v235, v46, v47
buffer_store_dwordx4 v[232:235], v1, s[64:67], s80 offen offset:3072 sc1
v_pk_fma_f32 v[188:189], v[88:89], v[180:181], v[172:173] op_sel_hi:[1,0,1] neg_lo:[0,1,0] neg_hi:[0,1,0]
v_pk_fma_f32 v[190:191], v[90:91], v[180:181], v[174:175] op_sel_hi:[1,0,1] neg_lo:[0,1,0] neg_hi:[0,1,0]
v_pk_fma_f32 v[192:193], v[92:93], v[180:181], v[176:177] op_sel_hi:[1,0,1] neg_lo:[0,1,0] neg_hi:[0,1,0]
v_pk_fma_f32 v[194:195], v[94:95], v[180:181], v[178:179] op_sel_hi:[1,0,1] neg_lo:[0,1,0] neg_hi:[0,1,0]
v_pk_fma_f32 v[48:49], v[180:181], v[48:49], v[188:189] op_sel:[1,0,0]
v_pk_fma_f32 v[50:51], v[180:181], v[50:51], v[190:191] op_sel:[1,0,0]
v_pk_fma_f32 v[64:65], v[180:181], v[64:65], v[192:193] op_sel:[1,0,0]
v_pk_fma_f32 v[66:67], v[180:181], v[66:67], v[194:195] op_sel:[1,0,0]
v_pk_fma_f32 v[188:189], v[48:49], v[48:49], v[12:13] op_sel_hi:[1,1,0]
v_pk_fma_f32 v[190:191], v[50:51], v[50:51], v[12:13] op_sel_hi:[1,1,0]
v_pk_fma_f32 v[192:193], v[64:65], v[64:65], v[12:13] op_sel_hi:[1,1,0]
v_pk_fma_f32 v[194:195], v[66:67], v[66:67], v[12:13] op_sel_hi:[1,1,0]
v_pk_mul_f32 v[188:189], v[188:189], v[48:49]
v_pk_mul_f32 v[190:191], v[190:191], v[50:51]
v_pk_mul_f32 v[192:193], v[192:193], v[64:65]
v_pk_mul_f32 v[194:195], v[194:195], v[66:67]
v_exp_f32 v188, v188
v_exp_f32 v189, v189
v_exp_f32 v190, v190
v_exp_f32 v191, v191
v_exp_f32 v192, v192
v_exp_f32 v193, v193
v_exp_f32 v194, v194
v_exp_f32 v195, v195
v_pk_fma_f32 v[188:189], v[12:13], v[188:189], v[12:13] op_sel:[1,0,1]
v_pk_fma_f32 v[190:191], v[12:13], v[190:191], v[12:13] op_sel:[1,0,1]
v_pk_fma_f32 v[192:193], v[12:13], v[192:193], v[12:13] op_sel:[1,0,1]
v_pk_fma_f32 v[194:195], v[12:13], v[194:195], v[12:13] op_sel:[1,0,1]
v_rcp_f32 v188, v188
v_rcp_f32 v189, v189
v_rcp_f32 v190, v190
v_rcp_f32 v191, v191
v_rcp_f32 v192, v192
v_rcp_f32 v193, v193
v_rcp_f32 v194, v194
v_rcp_f32 v195, v195
v_pk_mul_f32 v[48:49], v[48:49], v[188:189]
v_pk_mul_f32 v[50:51], v[50:51], v[190:191]
v_pk_mul_f32 v[64:65], v[64:65], v[192:193]
v_pk_mul_f32 v[66:67], v[66:67], v[194:195]
v_cvt_pk_bf16_f32 v228, v48, v49
v_cvt_pk_bf16_f32 v229, v50, v51
v_cvt_pk_bf16_f32 v230, v64, v65
v_cvt_pk_bf16_f32 v231, v66, v67
buffer_store_dwordx4 v[228:231], v1, s[64:67], s81 offen offset:0 sc1
v_pk_fma_f32 v[196:197], v[88:89], v[182:183], v[172:173] op_sel_hi:[1,0,1] neg_lo:[0,1,0] neg_hi:[0,1,0]
v_pk_fma_f32 v[198:199], v[90:91], v[182:183], v[174:175] op_sel_hi:[1,0,1] neg_lo:[0,1,0] neg_hi:[0,1,0]
v_pk_fma_f32 v[200:201], v[92:93], v[182:183], v[176:177] op_sel_hi:[1,0,1] neg_lo:[0,1,0] neg_hi:[0,1,0]
v_pk_fma_f32 v[202:203], v[94:95], v[182:183], v[178:179] op_sel_hi:[1,0,1] neg_lo:[0,1,0] neg_hi:[0,1,0]
v_pk_fma_f32 v[52:53], v[182:183], v[52:53], v[196:197] op_sel:[1,0,0]
v_pk_fma_f32 v[54:55], v[182:183], v[54:55], v[198:199] op_sel:[1,0,0]
v_pk_fma_f32 v[68:69], v[182:183], v[68:69], v[200:201] op_sel:[1,0,0]
v_pk_fma_f32 v[70:71], v[182:183], v[70:71], v[202:203] op_sel:[1,0,0]
v_pk_fma_f32 v[196:197], v[52:53], v[52:53], v[12:13] op_sel_hi:[1,1,0]
v_pk_fma_f32 v[198:199], v[54:55], v[54:55], v[12:13] op_sel_hi:[1,1,0]
v_pk_fma_f32 v[200:201], v[68:69], v[68:69], v[12:13] op_sel_hi:[1,1,0]
v_pk_fma_f32 v[202:203], v[70:71], v[70:71], v[12:13] op_sel_hi:[1,1,0]
v_pk_mul_f32 v[196:197], v[196:197], v[52:53]
v_pk_mul_f32 v[198:199], v[198:199], v[54:55]
v_pk_mul_f32 v[200:201], v[200:201], v[68:69]
v_pk_mul_f32 v[202:203], v[202:203], v[70:71]
v_exp_f32 v196, v196
v_exp_f32 v197, v197
v_exp_f32 v198, v198
v_exp_f32 v199, v199
v_exp_f32 v200, v200
v_exp_f32 v201, v201
v_exp_f32 v202, v202
v_exp_f32 v203, v203
v_pk_fma_f32 v[196:197], v[12:13], v[196:197], v[12:13] op_sel:[1,0,1]
v_pk_fma_f32 v[198:199], v[12:13], v[198:199], v[12:13] op_sel:[1,0,1]
v_pk_fma_f32 v[200:201], v[12:13], v[200:201], v[12:13] op_sel:[1,0,1]
v_pk_fma_f32 v[202:203], v[12:13], v[202:203], v[12:13] op_sel:[1,0,1]
v_rcp_f32 v196, v196
v_rcp_f32 v197, v197
v_rcp_f32 v198, v198
v_rcp_f32 v199, v199
v_rcp_f32 v200, v200
v_rcp_f32 v201, v201
v_rcp_f32 v202, v202
v_rcp_f32 v203, v203
v_pk_mul_f32 v[52:53], v[52:53], v[196:197]
v_pk_mul_f32 v[54:55], v[54:55], v[198:199]
v_pk_mul_f32 v[68:69], v[68:69], v[200:201]
v_pk_mul_f32 v[70:71], v[70:71], v[202:203]
v_cvt_pk_bf16_f32 v232, v52, v53
v_cvt_pk_bf16_f32 v233, v54, v55
v_cvt_pk_bf16_f32 v234, v68, v69
v_cvt_pk_bf16_f32 v235, v70, v71
buffer_store_dwordx4 v[232:235], v1, s[64:67], s81 offen offset:1024 sc1
v_pk_fma_f32 v[188:189], v[88:89], v[184:185], v[172:173] op_sel_hi:[1,0,1] neg_lo:[0,1,0] neg_hi:[0,1,0]
v_pk_fma_f32 v[190:191], v[90:91], v[184:185], v[174:175] op_sel_hi:[1,0,1] neg_lo:[0,1,0] neg_hi:[0,1,0]
v_pk_fma_f32 v[192:193], v[92:93], v[184:185], v[176:177] op_sel_hi:[1,0,1] neg_lo:[0,1,0] neg_hi:[0,1,0]
v_pk_fma_f32 v[194:195], v[94:95], v[184:185], v[178:179] op_sel_hi:[1,0,1] neg_lo:[0,1,0] neg_hi:[0,1,0]
v_pk_fma_f32 v[56:57], v[184:185], v[56:57], v[188:189] op_sel:[1,0,0]
v_pk_fma_f32 v[58:59], v[184:185], v[58:59], v[190:191] op_sel:[1,0,0]
v_pk_fma_f32 v[72:73], v[184:185], v[72:73], v[192:193] op_sel:[1,0,0]
v_pk_fma_f32 v[74:75], v[184:185], v[74:75], v[194:195] op_sel:[1,0,0]
v_pk_fma_f32 v[188:189], v[56:57], v[56:57], v[12:13] op_sel_hi:[1,1,0]
v_pk_fma_f32 v[190:191], v[58:59], v[58:59], v[12:13] op_sel_hi:[1,1,0]
v_pk_fma_f32 v[192:193], v[72:73], v[72:73], v[12:13] op_sel_hi:[1,1,0]
v_pk_fma_f32 v[194:195], v[74:75], v[74:75], v[12:13] op_sel_hi:[1,1,0]
v_pk_mul_f32 v[188:189], v[188:189], v[56:57]
v_pk_mul_f32 v[190:191], v[190:191], v[58:59]
v_pk_mul_f32 v[192:193], v[192:193], v[72:73]
v_pk_mul_f32 v[194:195], v[194:195], v[74:75]
v_exp_f32 v188, v188
v_exp_f32 v189, v189
v_exp_f32 v190, v190
v_exp_f32 v191, v191
v_exp_f32 v192, v192
v_exp_f32 v193, v193
v_exp_f32 v194, v194
v_exp_f32 v195, v195
v_pk_fma_f32 v[188:189], v[12:13], v[188:189], v[12:13] op_sel:[1,0,1]
v_pk_fma_f32 v[190:191], v[12:13], v[190:191], v[12:13] op_sel:[1,0,1]
v_pk_fma_f32 v[192:193], v[12:13], v[192:193], v[12:13] op_sel:[1,0,1]
v_pk_fma_f32 v[194:195], v[12:13], v[194:195], v[12:13] op_sel:[1,0,1]
v_rcp_f32 v188, v188
v_rcp_f32 v189, v189
v_rcp_f32 v190, v190
v_rcp_f32 v191, v191
v_rcp_f32 v192, v192
v_rcp_f32 v193, v193
v_rcp_f32 v194, v194
v_rcp_f32 v195, v195
v_pk_mul_f32 v[56:57], v[56:57], v[188:189]
v_pk_mul_f32 v[58:59], v[58:59], v[190:191]
v_pk_mul_f32 v[72:73], v[72:73], v[192:193]
v_pk_mul_f32 v[74:75], v[74:75], v[194:195]
v_cvt_pk_bf16_f32 v228, v56, v57
v_cvt_pk_bf16_f32 v229, v58, v59
v_cvt_pk_bf16_f32 v230, v72, v73
v_cvt_pk_bf16_f32 v231, v74, v75
buffer_store_dwordx4 v[228:231], v1, s[64:67], s81 offen offset:2048 sc1
ds_read_b32 v248, v227 offset:0
v_pk_fma_f32 v[196:197], v[88:89], v[186:187], v[172:173] op_sel_hi:[1,0,1] neg_lo:[0,1,0] neg_hi:[0,1,0]
v_pk_fma_f32 v[198:199], v[90:91], v[186:187], v[174:175] op_sel_hi:[1,0,1] neg_lo:[0,1,0] neg_hi:[0,1,0]
v_pk_fma_f32 v[200:201], v[92:93], v[186:187], v[176:177] op_sel_hi:[1,0,1] neg_lo:[0,1,0] neg_hi:[0,1,0]
v_pk_fma_f32 v[202:203], v[94:95], v[186:187], v[178:179] op_sel_hi:[1,0,1] neg_lo:[0,1,0] neg_hi:[0,1,0]
v_pk_fma_f32 v[60:61], v[186:187], v[60:61], v[196:197] op_sel:[1,0,0]
v_pk_fma_f32 v[62:63], v[186:187], v[62:63], v[198:199] op_sel:[1,0,0]
v_pk_fma_f32 v[76:77], v[186:187], v[76:77], v[200:201] op_sel:[1,0,0]
v_pk_fma_f32 v[78:79], v[186:187], v[78:79], v[202:203] op_sel:[1,0,0]
v_pk_fma_f32 v[196:197], v[60:61], v[60:61], v[12:13] op_sel_hi:[1,1,0]
v_pk_fma_f32 v[198:199], v[62:63], v[62:63], v[12:13] op_sel_hi:[1,1,0]
v_pk_fma_f32 v[200:201], v[76:77], v[76:77], v[12:13] op_sel_hi:[1,1,0]
v_pk_fma_f32 v[202:203], v[78:79], v[78:79], v[12:13] op_sel_hi:[1,1,0]
v_pk_mul_f32 v[196:197], v[196:197], v[60:61]
v_pk_mul_f32 v[198:199], v[198:199], v[62:63]
v_pk_mul_f32 v[200:201], v[200:201], v[76:77]
v_pk_mul_f32 v[202:203], v[202:203], v[78:79]
v_exp_f32 v196, v196
v_exp_f32 v197, v197
v_exp_f32 v198, v198
v_exp_f32 v199, v199
v_exp_f32 v200, v200
v_exp_f32 v201, v201
v_exp_f32 v202, v202
v_exp_f32 v203, v203
v_pk_fma_f32 v[196:197], v[12:13], v[196:197], v[12:13] op_sel:[1,0,1]
v_pk_fma_f32 v[198:199], v[12:13], v[198:199], v[12:13] op_sel:[1,0,1]
v_pk_fma_f32 v[200:201], v[12:13], v[200:201], v[12:13] op_sel:[1,0,1]
v_pk_fma_f32 v[202:203], v[12:13], v[202:203], v[12:13] op_sel:[1,0,1]
s_waitcnt lgkmcnt(0)
v_cmp_ne_u32 vcc, 4, v248
s_mov_b32 s94, 0
s_cbranch_vccnz Lck_1005
Lckb_1006:
v_rcp_f32 v196, v196
ds_read_b128 v[128:131], v209 offset:3584
v_rcp_f32 v197, v197
ds_read_b64 v[96:97], v208 offset:0
v_rcp_f32 v198, v198
ds_read_b64 v[98:99], v208 offset:8
v_rcp_f32 v199, v199
ds_read_b128 v[132:135], v209 offset:3072
v_rcp_f32 v200, v200
ds_read_b64 v[100:101], v208 offset:512
v_rcp_f32 v201, v201
ds_read_b64 v[102:103], v208 offset:520
v_rcp_f32 v202, v202
ds_read_b128 v[136:139], v209 offset:2560
v_rcp_f32 v203, v203
ds_read_b64 v[104:105], v208 offset:1024
v_pk_mul_f32 v[60:61], v[60:61], v[196:197]
v_pk_mul_f32 v[62:63], v[62:63], v[198:199]
v_pk_mul_f32 v[76:77], v[76:77], v[200:201]
v_pk_mul_f32 v[78:79], v[78:79], v[202:203]
v_cvt_pk_bf16_f32 v232, v60, v61
v_cvt_pk_bf16_f32 v233, v62, v63
v_cvt_pk_bf16_f32 v234, v76, v77
v_cvt_pk_bf16_f32 v235, v78, v79
buffer_store_dwordx4 v[232:235], v1, s[64:67], s81 offen offset:3072 sc1
s_setprio 0
L_Mj:
ds_read_b64 v[106:107], v208 offset:1032
s_waitcnt lgkmcnt(8)
v_mfma_f32_16x16x32_bf16 v[16:19], v[210:213], v[128:131], 0
ds_read_b128 v[140:143], v209 offset:2048
s_waitcnt lgkmcnt(7)
v_mfma_f32_16x16x32_bf16 v[16:19], v[96:99], v[128:131], v[16:19]
ds_read_b64 v[108:109], v208 offset:1536
s_waitcnt lgkmcnt(7)
v_mfma_f32_16x16x32_bf16 v[20:23], v[210:213], v[132:135], 0
ds_read_b64 v[110:111], v208 offset:1544
v_mfma_f32_16x16x32_bf16 v[20:23], v[96:99], v[132:135], v[20:23]
ds_read_b128 v[144:147], v209 offset:1536
s_waitcnt lgkmcnt(7)
v_mfma_f32_16x16x32_bf16 v[20:23], v[100:103], v[128:131], v[20:23]
ds_read_b64 v[112:113], v208 offset:2048
s_waitcnt lgkmcnt(7)
v_mfma_f32_16x16x32_bf16 v[24:27], v[210:213], v[136:139], 0
ds_read_b64 v[114:115], v208 offset:2056
v_mfma_f32_16x16x32_bf16 v[24:27], v[96:99], v[136:139], v[24:27]
ds_read_b128 v[148:151], v209 offset:1024
v_mfma_f32_16x16x32_bf16 v[24:27], v[100:103], v[132:135], v[24:27]
ds_read_b64 v[116:117], v208 offset:2560
s_waitcnt lgkmcnt(8)
v_mfma_f32_16x16x32_bf16 v[24:27], v[104:107], v[128:131], v[24:27]
ds_read_b64 v[118:119], v208 offset:2568
s_waitcnt lgkmcnt(8)
v_mfma_f32_16x16x32_bf16 v[28:31], v[210:213], v[140:143], 0
ds_read_b128 v[152:155], v209 offset:512
v_mfma_f32_16x16x32_bf16 v[28:31], v[96:99], v[140:143], v[28:31]
ds_read_b64 v[120:121], v208 offset:3072
v_mfma_f32_16x16x32_bf16 v[28:31], v[100:103], v[136:139], v[28:31]
ds_read_b64 v[122:123], v208 offset:3080
v_mfma_f32_16x16x32_bf16 v[28:31], v[104:107], v[132:135], v[28:31]
ds_read_b128 v[156:159], v209 offset:0
s_waitcnt lgkmcnt(10)
v_mfma_f32_16x16x32_bf16 v[28:31], v[108:111], v[128:131], v[28:31]
ds_read_b64 v[124:125], v208 offset:3584
s_waitcnt lgkmcnt(10)
v_mfma_f32_16x16x32_bf16 v[32:35], v[210:213], v[144:147], 0
ds_read_b64 v[126:127], v208 offset:3592
v_mfma_f32_16x16x32_bf16 v[32:35], v[96:99], v[144:147], v[32:35]
ds_read_b128 v[160:163], v209 offset:3648
s_waitcnt vmcnt(4)
s_atomic_add s82, s[30:31], s95
v_mfma_f32_16x16x32_bf16 v[32:35], v[100:103], v[140:143], v[32:35]
ds_read_b64 v[48:49], v208 offset:64
v_mfma_f32_16x16x32_bf16 v[32:35], v[104:107], v[136:139], v[32:35]
ds_read_b64 v[50:51], v208 offset:72
v_mfma_f32_16x16x32_bf16 v[32:35], v[108:111], v[132:135], v[32:35]
s_waitcnt lgkmcnt(13)
ds_read_b128 v[164:167], v209 offset:3136
s_waitcnt lgkmcnt(13)
v_mfma_f32_16x16x32_bf16 v[32:35], v[112:115], v[128:131], v[32:35]
ds_read_b64 v[52:53], v208 offset:576
s_waitcnt lgkmcnt(13)
v_mfma_f32_16x16x32_bf16 v[36:39], v[210:213], v[148:151], 0
ds_read_b64 v[54:55], v208 offset:584
v_mfma_f32_16x16x32_bf16 v[36:39], v[96:99], v[148:151], v[36:39]
s_waitcnt lgkmcnt(13)
ds_read_b128 v[168:171], v209 offset:2624
v_mfma_f32_16x16x32_bf16 v[36:39], v[100:103], v[144:147], v[36:39]
s_waitcnt lgkmcnt(13)
ds_read_b64 v[56:57], v208 offset:1088
v_mfma_f32_16x16x32_bf16 v[36:39], v[104:107], v[140:143], v[36:39]
s_waitcnt lgkmcnt(13)
ds_read_b64 v[58:59], v208 offset:1096
v_mfma_f32_16x16x32_bf16 v[36:39], v[108:111], v[136:139], v[36:39]
s_waitcnt lgkmcnt(13)
ds_read_b128 v[172:175], v209 offset:2112
v_mfma_f32_16x16x32_bf16 v[36:39], v[112:115], v[132:135], v[36:39]
s_waitcnt lgkmcnt(13)
ds_read_b64 v[60:61], v208 offset:1600
v_mfma_f32_16x16x32_bf16 v[36:39], v[116:119], v[128:131], v[36:39]
s_waitcnt lgkmcnt(13)
ds_read_b64 v[62:63], v208 offset:1608
v_mfma_f32_16x16x32_bf16 v[40:43], v[210:213], v[152:155], 0
s_waitcnt lgkmcnt(13)
ds_read_b128 v[176:179], v209 offset:1600
v_mfma_f32_16x16x32_bf16 v[40:43], v[96:99], v[152:155], v[40:43]
s_waitcnt lgkmcnt(13)
ds_read_b64 v[64:65], v208 offset:2112
v_mfma_f32_16x16x32_bf16 v[40:43], v[100:103], v[148:151], v[40:43]
s_waitcnt lgkmcnt(13)
ds_read_b64 v[66:67], v208 offset:2120
v_mfma_f32_16x16x32_bf16 v[40:43], v[104:107], v[144:147], v[40:43]
s_waitcnt lgkmcnt(13)
ds_read_b128 v[180:183], v209 offset:1088
v_mfma_f32_16x16x32_bf16 v[40:43], v[108:111], v[140:143], v[40:43]
s_waitcnt lgkmcnt(13)
ds_read_b64 v[68:69], v208 offset:2624
v_mfma_f32_16x16x32_bf16 v[40:43], v[112:115], v[136:139], v[40:43]
s_waitcnt lgkmcnt(13)
ds_read_b64 v[70:71], v208 offset:2632
v_mfma_f32_16x16x32_bf16 v[40:43], v[116:119], v[132:135], v[40:43]
s_waitcnt lgkmcnt(13)
ds_read_b128 v[184:187], v209 offset:576
v_mfma_f32_16x16x32_bf16 v[40:43], v[120:123], v[128:131], v[40:43]
s_waitcnt lgkmcnt(13)
ds_read_b64 v[72:73], v208 offset:3136
v_mfma_f32_16x16x32_bf16 v[44:47], v[210:213], v[156:159], 0
s_waitcnt lgkmcnt(13)
ds_read_b64 v[74:75], v208 offset:3144
v_mfma_f32_16x16x32_bf16 v[44:47], v[96:99], v[156:159], v[44:47]
s_waitcnt lgkmcnt(13)
ds_read_b128 v[188:191], v209 offset:64
v_mfma_f32_16x16x32_bf16 v[44:47], v[100:103], v[152:155], v[44:47]
s_waitcnt lgkmcnt(13)
ds_read_b64 v[76:77], v208 offset:3648
v_mfma_f32_16x16x32_bf16 v[44:47], v[104:107], v[148:151], v[44:47]
s_waitcnt lgkmcnt(13)
ds_read_b64 v[78:79], v208 offset:3656
v_mfma_f32_16x16x32_bf16 v[44:47], v[108:111], v[144:147], v[44:47]
v_mfma_f32_16x16x32_bf16 v[44:47], v[112:115], v[140:143], v[44:47]
v_mfma_f32_16x16x32_bf16 v[44:47], v[116:119], v[136:139], v[44:47]
v_mfma_f32_16x16x32_bf16 v[44:47], v[120:123], v[132:135], v[44:47]
v_mfma_f32_16x16x32_bf16 v[44:47], v[124:127], v[128:131], v[44:47]
v_mfma_f32_16x16x32_bf16 v[16:19], v[48:51], v[160:163], v[16:19]
s_waitcnt lgkmcnt(13)
ds_read_b128 v[128:131], v209 offset:3712
v_mfma_f32_16x16x32_bf16 v[20:23], v[48:51], v[164:167], v[20:23]
s_waitcnt lgkmcnt(13)
ds_read_b64 v[96:97], v208 offset:128
v_mfma_f32_16x16x32_bf16 v[20:23], v[52:55], v[160:163], v[20:23]
s_waitcnt lgkmcnt(13)
ds_read_b64 v[98:99], v208 offset:136
v_mfma_f32_16x16x32_bf16 v[24:27], v[48:51], v[168:171], v[24:27]
s_waitcnt lgkmcnt(13)
ds_read_b128 v[132:135], v209 offset:3200
v_mfma_f32_16x16x32_bf16 v[24:27], v[52:55], v[164:167], v[24:27]
s_waitcnt lgkmcnt(13)
ds_read_b64 v[100:101], v208 offset:640
v_mfma_f32_16x16x32_bf16 v[24:27], v[56:59], v[160:163], v[24:27]
s_waitcnt lgkmcnt(13)
ds_read_b64 v[102:103], v208 offset:648
v_mfma_f32_16x16x32_bf16 v[28:31], v[48:51], v[172:175], v[28:31]
s_waitcnt lgkmcnt(13)
ds_read_b128 v[136:139], v209 offset:2688
v_mfma_f32_16x16x32_bf16 v[28:31], v[52:55], v[168:171], v[28:31]
s_waitcnt lgkmcnt(13)
ds_read_b64 v[104:105], v208 offset:1152
v_mfma_f32_16x16x32_bf16 v[28:31], v[56:59], v[164:167], v[28:31]
s_waitcnt lgkmcnt(13)
ds_read_b64 v[106:107], v208 offset:1160
v_mfma_f32_16x16x32_bf16 v[28:31], v[60:63], v[160:163], v[28:31]
s_waitcnt lgkmcnt(13)
ds_read_b128 v[140:143], v209 offset:2176
v_mfma_f32_16x16x32_bf16 v[32:35], v[48:51], v[176:179], v[32:35]
s_waitcnt lgkmcnt(13)
ds_read_b64 v[108:109], v208 offset:1664
v_mfma_f32_16x16x32_bf16 v[32:35], v[52:55], v[172:175], v[32:35]
s_waitcnt lgkmcnt(13)
ds_read_b64 v[110:111], v208 offset:1672
v_mfma_f32_16x16x32_bf16 v[32:35], v[56:59], v[168:171], v[32:35]
s_waitcnt lgkmcnt(13)
ds_read_b128 v[144:147], v209 offset:1664
v_mfma_f32_16x16x32_bf16 v[32:35], v[60:63], v[164:167], v[32:35]
s_waitcnt lgkmcnt(13)
ds_read_b64 v[112:113], v208 offset:2176
v_mfma_f32_16x16x32_bf16 v[32:35], v[64:67], v[160:163], v[32:35]
s_waitcnt lgkmcnt(13)
ds_read_b64 v[114:115], v208 offset:2184
v_mfma_f32_16x16x32_bf16 v[36:39], v[48:51], v[180:183], v[36:39]
s_waitcnt lgkmcnt(13)
ds_read_b128 v[148:151], v209 offset:1152
v_mfma_f32_16x16x32_bf16 v[36:39], v[52:55], v[176:179], v[36:39]
s_waitcnt lgkmcnt(13)
ds_read_b64 v[116:117], v208 offset:2688
v_mfma_f32_16x16x32_bf16 v[36:39], v[56:59], v[172:175], v[36:39]
s_waitcnt lgkmcnt(13)
ds_read_b64 v[118:119], v208 offset:2696
v_mfma_f32_16x16x32_bf16 v[36:39], v[60:63], v[168:171], v[36:39]
s_waitcnt lgkmcnt(13)
ds_read_b128 v[152:155], v209 offset:640
v_mfma_f32_16x16x32_bf16 v[36:39], v[64:67], v[164:167], v[36:39]
s_waitcnt lgkmcnt(13)
ds_read_b64 v[120:121], v208 offset:3200
v_mfma_f32_16x16x32_bf16 v[36:39], v[68:71], v[160:163], v[36:39]
s_waitcnt lgkmcnt(13)
ds_read_b64 v[122:123], v208 offset:3208
v_mfma_f32_16x16x32_bf16 v[40:43], v[48:51], v[184:187], v[40:43]
s_waitcnt lgkmcnt(13)
ds_read_b128 v[156:159], v209 offset:128
v_mfma_f32_16x16x32_bf16 v[40:43], v[52:55], v[180:183], v[40:43]
s_waitcnt lgkmcnt(13)
ds_read_b64 v[124:125], v208 offset:3712
v_mfma_f32_16x16x32_bf16 v[40:43], v[56:59], v[176:179], v[40:43]
s_waitcnt lgkmcnt(13)
ds_read_b64 v[126:127], v208 offset:3720
s_waitcnt vmcnt(0)
s_lshl_b32 s3, s82, 8
s_atomic_add s3, s[30:31], s95
v_mfma_f32_16x16x32_bf16 v[40:43], v[60:63], v[172:175], v[40:43]
v_mfma_f32_16x16x32_bf16 v[40:43], v[64:67], v[168:171], v[40:43]
v_mfma_f32_16x16x32_bf16 v[40:43], v[68:71], v[164:167], v[40:43]
v_mfma_f32_16x16x32_bf16 v[40:43], v[72:75], v[160:163], v[40:43]
v_mfma_f32_16x16x32_bf16 v[44:47], v[48:51], v[188:191], v[44:47]
v_mfma_f32_16x16x32_bf16 v[44:47], v[52:55], v[184:187], v[44:47]
v_mfma_f32_16x16x32_bf16 v[44:47], v[56:59], v[180:183], v[44:47]
v_mfma_f32_16x16x32_bf16 v[44:47], v[60:63], v[176:179], v[44:47]
v_mfma_f32_16x16x32_bf16 v[44:47], v[64:67], v[172:175], v[44:47]
v_mfma_f32_16x16x32_bf16 v[44:47], v[68:71], v[168:171], v[44:47]
v_mfma_f32_16x16x32_bf16 v[44:47], v[72:75], v[164:167], v[44:47]
v_mfma_f32_16x16x32_bf16 v[44:47], v[76:79], v[160:163], v[44:47]
v_mfma_f32_16x16x32_bf16 v[16:19], v[96:99], v[128:131], v[16:19]
s_waitcnt lgkmcnt(13)
ds_read_b128 v[160:163], v209 offset:3776
v_mfma_f32_16x16x32_bf16 v[20:23], v[96:99], v[132:135], v[20:23]
s_waitcnt lgkmcnt(13)
ds_read_b64 v[48:49], v208 offset:192
v_mfma_f32_16x16x32_bf16 v[20:23], v[100:103], v[128:131], v[20:23]
s_waitcnt lgkmcnt(13)
ds_read_b64 v[50:51], v208 offset:200
v_mfma_f32_16x16x32_bf16 v[24:27], v[96:99], v[136:139], v[24:27]
s_waitcnt lgkmcnt(13)
ds_read_b128 v[164:167], v209 offset:3264
v_mfma_f32_16x16x32_bf16 v[24:27], v[100:103], v[132:135], v[24:27]
s_waitcnt lgkmcnt(13)
ds_read_b64 v[52:53], v208 offset:704
v_mfma_f32_16x16x32_bf16 v[24:27], v[104:107], v[128:131], v[24:27]
s_waitcnt lgkmcnt(13)
ds_read_b64 v[54:55], v208 offset:712
v_mfma_f32_16x16x32_bf16 v[28:31], v[96:99], v[140:143], v[28:31]
s_waitcnt lgkmcnt(13)
ds_read_b128 v[168:171], v209 offset:2752
v_mfma_f32_16x16x32_bf16 v[28:31], v[100:103], v[136:139], v[28:31]
s_waitcnt lgkmcnt(13)
ds_read_b64 v[56:57], v208 offset:1216
v_mfma_f32_16x16x32_bf16 v[28:31], v[104:107], v[132:135], v[28:31]
s_waitcnt lgkmcnt(13)
ds_read_b64 v[58:59], v208 offset:1224
v_mfma_f32_16x16x32_bf16 v[28:31], v[108:111], v[128:131], v[28:31]
s_waitcnt lgkmcnt(13)
ds_read_b128 v[172:175], v209 offset:2240
v_mfma_f32_16x16x32_bf16 v[32:35], v[96:99], v[144:147], v[32:35]
s_waitcnt lgkmcnt(13)
ds_read_b64 v[60:61], v208 offset:1728
v_mfma_f32_16x16x32_bf16 v[32:35], v[100:103], v[140:143], v[32:35]
s_waitcnt lgkmcnt(13)
ds_read_b64 v[62:63], v208 offset:1736
v_mfma_f32_16x16x32_bf16 v[32:35], v[104:107], v[136:139], v[32:35]
s_waitcnt lgkmcnt(13)
ds_read_b128 v[176:179], v209 offset:1728
v_mfma_f32_16x16x32_bf16 v[32:35], v[108:111], v[132:135], v[32:35]
s_waitcnt lgkmcnt(13)
ds_read_b64 v[64:65], v208 offset:2240
v_mfma_f32_16x16x32_bf16 v[32:35], v[112:115], v[128:131], v[32:35]
s_waitcnt lgkmcnt(13)
ds_read_b64 v[66:67], v208 offset:2248
v_mfma_f32_16x16x32_bf16 v[36:39], v[96:99], v[148:151], v[36:39]
s_waitcnt lgkmcnt(13)
ds_read_b128 v[180:183], v209 offset:1216
v_mfma_f32_16x16x32_bf16 v[36:39], v[100:103], v[144:147], v[36:39]
s_waitcnt lgkmcnt(13)
ds_read_b64 v[68:69], v208 offset:2752
v_mfma_f32_16x16x32_bf16 v[36:39], v[104:107], v[140:143], v[36:39]
s_waitcnt lgkmcnt(13)
ds_read_b64 v[70:71], v208 offset:2760
v_mfma_f32_16x16x32_bf16 v[36:39], v[108:111], v[136:139], v[36:39]
s_waitcnt lgkmcnt(13)
ds_read_b128 v[184:187], v209 offset:704
v_mfma_f32_16x16x32_bf16 v[36:39], v[112:115], v[132:135], v[36:39]
s_waitcnt lgkmcnt(13)
ds_read_b64 v[72:73], v208 offset:3264
v_mfma_f32_16x16x32_bf16 v[36:39], v[116:119], v[128:131], v[36:39]
s_waitcnt lgkmcnt(13)
ds_read_b64 v[74:75], v208 offset:3272
v_mfma_f32_16x16x32_bf16 v[40:43], v[96:99], v[152:155], v[40:43]
s_waitcnt lgkmcnt(13)
ds_read_b128 v[188:191], v209 offset:192
v_mfma_f32_16x16x32_bf16 v[40:43], v[100:103], v[148:151], v[40:43]
s_waitcnt lgkmcnt(13)
ds_read_b64 v[76:77], v208 offset:3776
v_mfma_f32_16x16x32_bf16 v[40:43], v[104:107], v[144:147], v[40:43]
s_waitcnt lgkmcnt(13)
ds_read_b64 v[78:79], v208 offset:3784
v_mov_b32 v11, 1
s_mov_b64 exec, 1
s_waitcnt lgkmcnt(13)
ds_add_u32 v227, v11 offset:4
s_mov_b64 exec, -1
v_mfma_f32_16x16x32_bf16 v[40:43], v[108:111], v[140:143], v[40:43]
v_mfma_f32_16x16x32_bf16 v[40:43], v[112:115], v[136:139], v[40:43]
v_mfma_f32_16x16x32_bf16 v[40:43], v[116:119], v[132:135], v[40:43]
v_mfma_f32_16x16x32_bf16 v[40:43], v[120:123], v[128:131], v[40:43]
v_mfma_f32_16x16x32_bf16 v[44:47], v[96:99], v[156:159], v[44:47]
v_mfma_f32_16x16x32_bf16 v[44:47], v[100:103], v[152:155], v[44:47]
v_mfma_f32_16x16x32_bf16 v[44:47], v[104:107], v[148:151], v[44:47]
v_mfma_f32_16x16x32_bf16 v[44:47], v[108:111], v[144:147], v[44:47]
v_mfma_f32_16x16x32_bf16 v[44:47], v[112:115], v[140:143], v[44:47]
v_mfma_f32_16x16x32_bf16 v[44:47], v[116:119], v[136:139], v[44:47]
v_mfma_f32_16x16x32_bf16 v[44:47], v[120:123], v[132:135], v[44:47]
v_mfma_f32_16x16x32_bf16 v[44:47], v[124:127], v[128:131], v[44:47]
v_mfma_f32_16x16x32_bf16 v[16:19], v[48:51], v[160:163], v[16:19]
v_mfma_f32_16x16x32_bf16 v[20:23], v[48:51], v[164:167], v[20:23]
s_waitcnt lgkmcnt(13)
ds_read_b32 v10, v227 offset:4
v_mfma_f32_16x16x32_bf16 v[20:23], v[52:55], v[160:163], v[20:23]
v_mfma_f32_16x16x32_bf16 v[24:27], v[48:51], v[168:171], v[24:27]
v_mfma_f32_16x16x32_bf16 v[24:27], v[52:55], v[164:167], v[24:27]
v_mfma_f32_16x16x32_bf16 v[24:27], v[56:59], v[160:163], v[24:27]
v_mfma_f32_16x16x32_bf16 v[28:31], v[48:51], v[172:175], v[28:31]
v_mfma_f32_16x16x32_bf16 v[28:31], v[52:55], v[168:171], v[28:31]
v_mfma_f32_16x16x32_bf16 v[28:31], v[56:59], v[164:167], v[28:31]
s_waitcnt lgkmcnt(0)
v_cmp_ne_u32 vcc, 4, v10
s_mov_b32 s94, 0
s_cbranch_vccnz Lck_1010
Lckb_1011:
v_mfma_f32_16x16x32_bf16 v[28:31], v[60:63], v[160:163], v[28:31]
ds_write_b128 v214, v[16:19] offset:0
v_mfma_f32_16x16x32_bf16 v[32:35], v[48:51], v[176:179], v[32:35]
ds_write_b128 v214, v[20:23] offset:1024
v_mfma_f32_16x16x32_bf16 v[32:35], v[52:55], v[172:175], v[32:35]
v_mfma_f32_16x16x32_bf16 v[32:35], v[56:59], v[168:171], v[32:35]
v_mfma_f32_16x16x32_bf16 v[32:35], v[60:63], v[164:167], v[32:35]
ds_write_b128 v214, v[24:27] offset:2048
v_mfma_f32_16x16x32_bf16 v[32:35], v[64:67], v[160:163], v[32:35]
v_mfma_f32_16x16x32_bf16 v[36:39], v[48:51], v[180:183], v[36:39]
v_mfma_f32_16x16x32_bf16 v[36:39], v[52:55], v[176:179], v[36:39]
v_mfma_f32_16x16x32_bf16 v[36:39], v[56:59], v[172:175], v[36:39]
ds_write_b128 v214, v[28:31] offset:3072
v_mfma_f32_16x16x32_bf16 v[36:39], v[60:63], v[168:171], v[36:39]
v_mfma_f32_16x16x32_bf16 v[36:39], v[64:67], v[164:167], v[36:39]
v_mfma_f32_16x16x32_bf16 v[36:39], v[68:71], v[160:163], v[36:39]
v_mfma_f32_16x16x32_bf16 v[40:43], v[48:51], v[184:187], v[40:43]
v_mfma_f32_16x16x32_bf16 v[40:43], v[52:55], v[180:183], v[40:43]
ds_write_b128 v214, v[32:35] offset:4096
v_mfma_f32_16x16x32_bf16 v[40:43], v[56:59], v[176:179], v[40:43]
v_mfma_f32_16x16x32_bf16 v[40:43], v[60:63], v[172:175], v[40:43]
v_mfma_f32_16x16x32_bf16 v[40:43], v[64:67], v[168:171], v[40:43]
v_mfma_f32_16x16x32_bf16 v[40:43], v[68:71], v[164:167], v[40:43]
v_mfma_f32_16x16x32_bf16 v[40:43], v[72:75], v[160:163], v[40:43]
v_mfma_f32_16x16x32_bf16 v[44:47], v[48:51], v[188:191], v[44:47]
ds_write_b128 v214, v[36:39] offset:5120
v_mfma_f32_16x16x32_bf16 v[44:47], v[52:55], v[184:187], v[44:47]
v_mfma_f32_16x16x32_bf16 v[44:47], v[56:59], v[180:183], v[44:47]
v_mfma_f32_16x16x32_bf16 v[44:47], v[60:63], v[176:179], v[44:47]
v_mfma_f32_16x16x32_bf16 v[44:47], v[64:67], v[172:175], v[44:47]
v_mfma_f32_16x16x32_bf16 v[44:47], v[68:71], v[168:171], v[44:47]
v_mfma_f32_16x16x32_bf16 v[44:47], v[72:75], v[164:167], v[44:47]
v_mfma_f32_16x16x32_bf16 v[44:47], v[76:79], v[160:163], v[44:47]
ds_write_b128 v214, v[40:43] offset:6144
s_nop 6
ds_write_b128 v214, v[44:47] offset:7168
s_mov_b64 exec, 1
ds_add_u32 v227, v11 offset:8
s_mov_b64 exec, -1
s_mov_b32 s94, 0
Lsy_1013:
ds_read_b32 v10, v227 offset:8
s_add_u32 s94, s94, 1
s_waitcnt lgkmcnt(0)
v_cmp_ne_u32 vcc, 4, v10
s_cmp_gt_u32 s94, 1048576
s_cbranch_scc1 Lsyd_1014
s_cbranch_vccnz Lsy_1013
Lsyd_1014:
ds_read_b128 v[48:51], v215 offset:0
ds_read_b128 v[52:55], v215 offset:8192
ds_read_b128 v[56:59], v215 offset:16384
ds_read_b128 v[60:63], v215 offset:24576
ds_read_b128 v[64:67], v215 offset:1024
ds_read_b128 v[68:71], v215 offset:9216
ds_read_b128 v[72:75], v215 offset:17408
ds_read_b128 v[76:79], v215 offset:25600
s_waitcnt lgkmcnt(4)
v_add_f32 v48, v48, v52
v_add_f32 v56, v56, v60
v_add_f32 v49, v49, v53
v_add_f32 v57, v57, v61
v_add_f32 v50, v50, v54
v_add_f32 v58, v58, v62
v_add_f32 v51, v51, v55
v_add_f32 v59, v59, v63
v_cvt_pk_bf16_f32 v52, v48, v56
v_cvt_pk_bf16_f32 v53, v49, v57
v_cvt_pk_bf16_f32 v54, v50, v58
v_cvt_pk_bf16_f32 v55, v51, v59
buffer_store_dwordx4 v[52:55], v216, s[64:67], 0 offen sc1
s_waitcnt lgkmcnt(0)
v_add_f32 v64, v64, v68
v_add_f32 v72, v72, v76
v_add_f32 v65, v65, v69
v_add_f32 v73, v73, v77
v_add_f32 v66, v66, v70
v_add_f32 v74, v74, v78
v_add_f32 v67, v67, v71
v_add_f32 v75, v75, v79
v_cvt_pk_bf16_f32 v68, v64, v72
v_cvt_pk_bf16_f32 v69, v65, v73
v_cvt_pk_bf16_f32 v70, v66, v74
v_cvt_pk_bf16_f32 v71, v67, v75
buffer_store_dwordx4 v[68:71], v216, s[64:67], 0 offen offset:1024 sc1
s_mov_b64 s[84:85], s[26:27]
s_mov_b32 s86, 2097152
s_mov_b32 s87, 0x20000
v_lshrrev_b32 v239, 4, v0
s_mov_b32 s89, 32768
s_lshl2_add_u32 s44, s33, s32
s_lshr_b32 s45, s34, 3
s_lshl2_add_u32 s44, s44, s45
s_add_u32 s44, s44, 256
s_lshl_b32 s83, s44, 8
s_lshr_b32 s44, s38, 3
s_lshl2_add_u32 s44, s39, s44
s_lshl2_add_u32 s44, s44, s32
s_add_u32 s44, s44, 256
s_lshl_b32 s17, s44, 8
s_lshl_b32 s45, s32, 1
v_and_b32 v10, 15, v0
v_xor_b32 v10, s45, v10
v_lshlrev_b32 v10, 4, v10
v_lshl_add_u32 v220, v239, 13, v10
v_xor_b32 v221, 16, v220
s_lshl_b32 s45, s39, 18
s_lshl_b32 s46, s38, 8
s_add_u32 s45, s45, s46
s_lshl_b32 s46, s32, 16
s_add_u32 s45, s45, s46
s_add_u32 s45, s45, 3145728
s_add_u32 s46, s45, 31744
v_add_u32 v220, s45, v220
v_add_u32 v221, s46, v221
v_lshrrev_b32 v236, 3, v0
v_and_b32 v237, 7, v0
v_and_b32 v238, 1, v236
v_bfe_u32 v10, v236, 1, 1
v_lshl_add_u32 v238, v10, 2, v238
v_lshrrev_b32 v12, 2, v236
v_lshl_add_u32 v238, v12, 1, v238
s_lshl_b32 s45, s38, 6
s_lshl3_add_u32 s45, s32, s45
v_add_u32 v13, s45, v238
s_lshl_b32 s46, s39, 7
v_lshl_add_u32 v219, v237, 4, s46
v_lshl_add_u32 v217, v13, 10, v219
v_lshlrev_b32 v219, 4, v237
v_add_u32 v219, 160960, v219
v_lshlrev_b32 v218, 3, v13
v_add_u32 v218, 131072, v218
s_lshl_b32 s44, s32, 2
s_or_b32 s44, s44, 1
v_xor_b32 v10, s44, v12
v_xor_b32 v10, v10, v237
v_lshlrev_b32 v10, 4, v10
v_lshl_add_u32 v10, v237, 10, v10
v_and_b32 v12, 3, v236
v_lshl_add_u32 v10, v12, 2, v10
v_xor_b32 v223, 32, v10
v_add_u32 v222, 150912, v10
v_add_u32 v223, 150912, v223
v_and_b32 v10, 3, v238
v_lshlrev_b32 v10, 8, v10
v_lshrrev_b32 v12, 2, v238
v_lshl_add_u32 v10, v12, 6, v10
v_and_b32 v12, 1, v237
v_lshl_add_u32 v10, v12, 5, v10
s_lshl_b32 s44, s98, 7
v_add_u32 v10, s44, v10
v_bfe_u32 v12, v237, 1, 1
v_lshl_add_u32 v10, v12, 4, v10
v_lshrrev_b32 v12, 2, v237
v_lshl_add_u32 v10, v12, 7, v10
v_lshrrev_b32 v12, 1, v237
v_lshl_add_u32 v10, v12, 13, v10
s_lshl_b32 s44, s99, 10
s_mul_i32 s45, s99, 24576
v_mov_b32 v224, s44
v_mov_b32 v13, s45
v_cmp_lt_u32 vcc, 1, v237
s_nop 0
s_nop 0
v_cndmask_b32 v224, v224, v13, vcc
v_add_u32 v224, v10, v224
v_add_u32 v225, 57344, v224
v_and_b32 v10, 1023, v218
v_add_u32 v10, 161152, v10
ds_read2_b64 v[24:27], v10 offset0:0 offset1:32
ds_read_b128 v[28:31], v219
s_add_u32 m0, s43, 150912
s_waitcnt vmcnt(0) lgkmcnt(0)
s_movk_i32 s3, 1
s_atomic_add s3, s[30:31], s83
v_min3_u32 v10, v24, v25, v26
v_min_u32 v10, v10, v27
v_cmp_eq_u32 vcc, 0, v10
s_mov_b32 s94, 0
s_cbranch_vccnz Ls2_1015
Ls2b_1016:
v_lshlrev_b32 v80, 16, v240
v_and_b32 v81, 0xffff0000, v240
v_lshlrev_b32 v82, 16, v241
v_and_b32 v83, 0xffff0000, v241
v_lshlrev_b32 v84, 16, v242
v_and_b32 v85, 0xffff0000, v242
v_lshlrev_b32 v86, 16, v243
v_and_b32 v87, 0xffff0000, v243
v_sub_f32 v96, v80, v24
v_sub_f32 v97, v81, v24
v_sub_f32 v98, v82, v24
v_sub_f32 v99, v83, v24
v_sub_f32 v100, v84, v24
v_sub_f32 v101, v85, v24
v_sub_f32 v102, v86, v24
v_sub_f32 v103, v87, v24
v_mul_f32 v96, v96, v25
v_mul_f32 v97, v97, v25
v_mul_f32 v98, v98, v25
v_mul_f32 v99, v99, v25
v_mul_f32 v100, v100, v25
v_mul_f32 v101, v101, v25
v_mul_f32 v102, v102, v25
v_mul_f32 v103, v103, v25
v_lshlrev_b32 v88, 16, v244
v_and_b32 v89, 0xffff0000, v244
v_lshlrev_b32 v90, 16, v245
v_and_b32 v91, 0xffff0000, v245
v_lshlrev_b32 v92, 16, v246
v_and_b32 v93, 0xffff0000, v246
v_lshlrev_b32 v94, 16, v247
v_and_b32 v95, 0xffff0000, v247
v_sub_f32 v104, v88, v26
v_sub_f32 v105, v89, v26
v_sub_f32 v106, v90, v26
v_sub_f32 v107, v91, v26
v_sub_f32 v108, v92, v26
v_sub_f32 v109, v93, v26
v_sub_f32 v110, v94, v26
v_sub_f32 v111, v95, v26
v_mul_f32 v104, v104, v27
v_mul_f32 v105, v105, v27
v_mul_f32 v106, v106, v27
v_mul_f32 v107, v107, v27
v_mul_f32 v108, v108, v27
v_mul_f32 v109, v109, v27
v_mul_f32 v110, v110, v27
v_mul_f32 v111, v111, v27
v_lshlrev_b32 v32, 16, v28
v_and_b32 v33, 0xffff0000, v28
v_lshlrev_b32 v34, 16, v29
v_and_b32 v35, 0xffff0000, v29
v_lshlrev_b32 v36, 16, v30
v_and_b32 v37, 0xffff0000, v30
v_lshlrev_b32 v38, 16, v31
v_and_b32 v39, 0xffff0000, v31
s_mov_b32 s94, 0
Lsp_1017:
s_load_dword s16, s[30:31], s17 glc
s_add_u32 s94, s94, 1
s_waitcnt lgkmcnt(0)
s_cmp_eq_u32 s16, 8
s_cbranch_scc1 Lspd_1018
s_cmp_gt_u32 s94, 131072
s_cbranch_scc0 Lsp_1017
Lspd_1018:
buffer_load_dwordx4 v220, s[64:67], 0 offen sc1 lds
buffer_load_dwordx4 v221, s[64:67], 0 offen offset:1024 sc1 lds
v_mov_b32 v12, 0xbfb8aa3b
s_mov_b32 s90, 0
s_mov_b32 s91, 0
s_mov_b32 s94, 0
Lf_1019:
s_getreg_b32 s44, hwreg(HW_REG_IB_STS, 0, 4)
s_or_b32 s44, s44, s90
s_cbranch_scc1 Lfn_1020
s_waitcnt vmcnt(0)
s_mov_b64 exec, 1
ds_add_u32 v227, v11 offset:12
s_mov_b64 exec, -1
s_mov_b32 s90, 1
Lfn_1020:
ds_read2_b32 v[178:179], v227 offset0:3 offset1:6
s_add_u32 s94, s94, 1
s_waitcnt lgkmcnt(0)
v_cmp_eq_u32 vcc, 4, v178
s_cmp_gt_u32 s94, 1048576
s_cbranch_vccnz Lfm_1021
s_cbranch_scc1 Lfd_1022
v_cmp_ne_u32 vcc, 4, v179
s_nop 0
s_cbranch_vccz Lfd_1022
s_sleep 1
s_branch Lf_1019
Lfm_1021:
ds_read2st64_b32 v[40:41], v222 offset0:0 offset1:1
ds_read2st64_b32 v[42:43], v222 offset0:2 offset1:3
ds_read2st64_b32 v[44:45], v223 offset0:0 offset1:1
ds_read2st64_b32 v[46:47], v223 offset0:2 offset1:3
s_waitcnt lgkmcnt(0)
v_lshlrev_b32 v176, 16, v40
v_and_b32 v177, 0xffff0000, v40
v_mul_f32 v96, v96, v176
v_mul_f32 v97, v97, v177
v_lshlrev_b32 v176, 16, v41
v_and_b32 v177, 0xffff0000, v41
v_mul_f32 v98, v98, v176
v_mul_f32 v99, v99, v177
v_lshlrev_b32 v176, 16, v42
v_and_b32 v177, 0xffff0000, v42
v_mul_f32 v100, v100, v176
v_mul_f32 v101, v101, v177
v_lshlrev_b32 v176, 16, v43
v_and_b32 v177, 0xffff0000, v43
v_mul_f32 v102, v102, v176
v_mul_f32 v103, v103, v177
v_lshlrev_b32 v176, 16, v44
v_and_b32 v177, 0xffff0000, v44
v_mul_f32 v104, v104, v176
v_mul_f32 v105, v105, v177
v_lshlrev_b32 v176, 16, v45
v_and_b32 v177, 0xffff0000, v45
v_mul_f32 v106, v106, v176
v_mul_f32 v107, v107, v177
v_lshlrev_b32 v176, 16, v46
v_and_b32 v177, 0xffff0000, v46
v_mul_f32 v108, v108, v176
v_mul_f32 v109, v109, v177
v_lshlrev_b32 v176, 16, v47
v_and_b32 v177, 0xffff0000, v47
v_mul_f32 v110, v110, v176
v_mul_f32 v111, v111, v177
s_mov_b32 s91, 1
s_mov_b32 s94, 0
Lsy_1024:
ds_read_b32 v10, v227 offset:24
s_add_u32 s94, s94, 1
s_waitcnt lgkmcnt(0)
v_cmp_ne_u32 vcc, 4, v10
s_cmp_gt_u32 s94, 1048576
s_cbranch_scc1 Lsyd_1025
s_cbranch_vccz Lsyd_1025
s_sleep 1
s_branch Lsy_1024
Lsyd_1025:
Lfd_1022:
ds_read_b128 v[112:115], v224 offset:0
ds_read_b128 v[116:119], v224 offset:16
ds_read_b128 v[120:123], v224 offset:2048
ds_read_b128 v[124:127], v224 offset:2064
ds_read_b128 v[128:131], v224 offset:4096
ds_read_b128 v[132:135], v224 offset:4112
ds_read_b128 v[136:139], v224 offset:6144
ds_read_b128 v[140:143], v224 offset:6160
s_waitcnt lgkmcnt(6)
.p2align 3
v_pk_add_f32 v[112:113], v[112:113], v[32:33]
v_pk_add_f32 v[114:115], v[114:115], v[34:35]
v_pk_add_f32 v[116:117], v[116:117], v[36:37]
v_pk_add_f32 v[118:119], v[118:119], v[38:39]
s_waitcnt lgkmcnt(2)
.p2align 3
v_pk_add_f32 v[120:121], v[120:121], v[128:129]
v_pk_add_f32 v[122:123], v[122:123], v[130:131]
v_pk_add_f32 v[124:125], v[124:125], v[132:133]
v_pk_add_f32 v[126:127], v[126:127], v[134:135]
s_waitcnt lgkmcnt(0)
.p2align 3
v_pk_add_f32 v[112:113], v[112:113], v[136:137]
v_pk_add_f32 v[114:115], v[114:115], v[138:139]
v_pk_add_f32 v[116:117], v[116:117], v[140:141]
v_pk_add_f32 v[118:119], v[118:119], v[142:143]
v_pk_add_f32 v[112:113], v[112:113], v[120:121]
v_pk_add_f32 v[114:115], v[114:115], v[122:123]
v_pk_add_f32 v[116:117], v[116:117], v[124:125]
v_pk_add_f32 v[118:119], v[118:119], v[126:127]
v_pk_mul_f32 v[176:177], v[112:113], v[12:13] op_sel_hi:[1,0]
v_pk_mul_f32 v[178:179], v[114:115], v[12:13] op_sel_hi:[1,0]
v_pk_mul_f32 v[180:181], v[116:117], v[12:13] op_sel_hi:[1,0]
v_pk_mul_f32 v[182:183], v[118:119], v[12:13] op_sel_hi:[1,0]
v_exp_f32 v176, v176
v_exp_f32 v177, v177
v_exp_f32 v178, v178
v_exp_f32 v179, v179
v_exp_f32 v180, v180
v_exp_f32 v181, v181
v_exp_f32 v182, v182
v_exp_f32 v183, v183
v_pk_add_f32 v[176:177], v[176:177], 1.0 op_sel_hi:[1,0]
v_pk_add_f32 v[178:179], v[178:179], 1.0 op_sel_hi:[1,0]
v_pk_add_f32 v[180:181], v[180:181], 1.0 op_sel_hi:[1,0]
v_pk_add_f32 v[182:183], v[182:183], 1.0 op_sel_hi:[1,0]
v_rcp_f32 v176, v176
v_rcp_f32 v177, v177
v_rcp_f32 v178, v178
v_rcp_f32 v179, v179
v_rcp_f32 v180, v180
v_rcp_f32 v181, v181
v_rcp_f32 v182, v182
v_rcp_f32 v183, v183
v_pk_mul_f32 v[112:113], v[112:113], v[176:177]
v_pk_mul_f32 v[114:115], v[114:115], v[178:179]
v_pk_mul_f32 v[116:117], v[116:117], v[180:181]
v_pk_mul_f32 v[118:119], v[118:119], v[182:183]
s_cmp_eq_u32 s91, 0
s_cbranch_scc1 Ly1_1026
v_pk_fma_f32 v[112:113], v[112:113], v[96:97], v[80:81]
v_pk_fma_f32 v[114:115], v[114:115], v[98:99], v[82:83]
v_pk_fma_f32 v[116:117], v[116:117], v[100:101], v[84:85]
v_pk_fma_f32 v[118:119], v[118:119], v[102:103], v[86:87]
v_cvt_pk_bf16_f32 v120, v112, v113
v_cvt_pk_bf16_f32 v121, v114, v115
v_cvt_pk_bf16_f32 v122, v116, v117
v_cvt_pk_bf16_f32 v123, v118, v119
buffer_store_dwordx4 v[120:123], v217, s[84:87], 0 offen sc1
s_branch Lym_1029
Ly1_1026:
s_getreg_b32 s44, hwreg(HW_REG_IB_STS, 0, 4)
s_or_b32 s44, s44, s90
s_cbranch_scc1 Lta_1030
s_waitcnt vmcnt(0)
s_mov_b64 exec, 1
ds_add_u32 v227, v11 offset:12
s_mov_b64 exec, -1
s_mov_b32 s90, 1
Lta_1030:
Lym_1029:
s_mov_b32 s94, 0
Lsy_1031:
ds_read_b32 v10, v227 offset:28
s_add_u32 s94, s94, 1
s_waitcnt lgkmcnt(0)
v_cmp_ne_u32 vcc, 4, v10
s_cmp_gt_u32 s94, 1048576
s_cbranch_scc1 Lsyd_1032
s_cbranch_vccnz Lsy_1031
Lsyd_1032:
ds_read_b128 v[144:147], v225 offset:0
ds_read_b128 v[148:151], v225 offset:16
ds_read_b128 v[152:155], v225 offset:2048
ds_read_b128 v[156:159], v225 offset:2064
ds_read_b128 v[160:163], v225 offset:4096
ds_read_b128 v[164:167], v225 offset:4112
ds_read_b128 v[168:171], v225 offset:6144
ds_read_b128 v[172:175], v225 offset:6160
ds_read_b32 v186, v227 offset:12
s_waitcnt lgkmcnt(6)
.p2align 3
v_pk_add_f32 v[144:145], v[144:145], v[32:33]
v_pk_add_f32 v[146:147], v[146:147], v[34:35]
v_pk_add_f32 v[148:149], v[148:149], v[36:37]
v_pk_add_f32 v[150:151], v[150:151], v[38:39]
s_waitcnt lgkmcnt(2)
.p2align 3
v_pk_add_f32 v[152:153], v[152:153], v[160:161]
v_pk_add_f32 v[154:155], v[154:155], v[162:163]
v_pk_add_f32 v[156:157], v[156:157], v[164:165]
v_pk_add_f32 v[158:159], v[158:159], v[166:167]
s_waitcnt lgkmcnt(0)
.p2align 3
v_pk_add_f32 v[144:145], v[144:145], v[168:169]
v_pk_add_f32 v[146:147], v[146:147], v[170:171]
v_pk_add_f32 v[148:149], v[148:149], v[172:173]
v_pk_add_f32 v[150:151], v[150:151], v[174:175]
v_pk_add_f32 v[144:145], v[144:145], v[152:153]
v_pk_add_f32 v[146:147], v[146:147], v[154:155]
v_pk_add_f32 v[148:149], v[148:149], v[156:157]
v_pk_add_f32 v[150:151], v[150:151], v[158:159]
v_pk_mul_f32 v[176:177], v[144:145], v[12:13] op_sel_hi:[1,0]
v_pk_mul_f32 v[178:179], v[146:147], v[12:13] op_sel_hi:[1,0]
v_pk_mul_f32 v[180:181], v[148:149], v[12:13] op_sel_hi:[1,0]
v_pk_mul_f32 v[182:183], v[150:151], v[12:13] op_sel_hi:[1,0]
s_cmp_lg_u32 s91, 0
s_cbranch_scc1 Lyq_1033
s_waitcnt lgkmcnt(0)
v_cmp_ne_u32 vcc, 4, v186
s_nop 0
s_cbranch_vccnz Lyq_1033
ds_read2st64_b32 v[40:41], v222 offset0:0 offset1:1
ds_read2st64_b32 v[42:43], v222 offset0:2 offset1:3
ds_read2st64_b32 v[44:45], v223 offset0:0 offset1:1
ds_read2st64_b32 v[46:47], v223 offset0:2 offset1:3
s_mov_b32 s91, 2
Lyq_1033:
v_exp_f32 v176, v176
v_exp_f32 v177, v177
v_exp_f32 v178, v178
v_exp_f32 v179, v179
v_exp_f32 v180, v180
v_exp_f32 v181, v181
v_exp_f32 v182, v182
v_exp_f32 v183, v183
v_pk_add_f32 v[176:177], v[176:177], 1.0 op_sel_hi:[1,0]
v_pk_add_f32 v[178:179], v[178:179], 1.0 op_sel_hi:[1,0]
v_pk_add_f32 v[180:181], v[180:181], 1.0 op_sel_hi:[1,0]
v_pk_add_f32 v[182:183], v[182:183], 1.0 op_sel_hi:[1,0]
v_rcp_f32 v176, v176
v_rcp_f32 v177, v177
v_rcp_f32 v178, v178
v_rcp_f32 v179, v179
v_rcp_f32 v180, v180
v_rcp_f32 v181, v181
v_rcp_f32 v182, v182
v_rcp_f32 v183, v183
v_pk_mul_f32 v[144:145], v[144:145], v[176:177]
v_pk_mul_f32 v[146:147], v[146:147], v[178:179]
v_pk_mul_f32 v[148:149], v[148:149], v[180:181]
v_pk_mul_f32 v[150:151], v[150:151], v[182:183]
s_cmp_eq_u32 s91, 1
s_cbranch_scc1 Ly2_1027
s_cmp_eq_u32 s91, 2
s_cbranch_scc1 Lyf_1034
s_cmp_lg_u32 s90, 0
s_cbranch_scc1 Lyn_1028
s_waitcnt vmcnt(0)
s_mov_b64 exec, 1
ds_add_u32 v227, v11 offset:12
s_mov_b64 exec, -1
s_mov_b32 s90, 1
Lyn_1028:
s_mov_b32 s94, 0
Lsy_1035:
ds_read_b32 v10, v227 offset:12
s_add_u32 s94, s94, 1
s_waitcnt lgkmcnt(0)
v_cmp_ne_u32 vcc, 4, v10
s_cmp_gt_u32 s94, 1048576
s_cbranch_scc1 Lsyd_1036
s_cbranch_vccnz Lsy_1035
Lsyd_1036:
ds_read2st64_b32 v[40:41], v222 offset0:0 offset1:1
ds_read2st64_b32 v[42:43], v222 offset0:2 offset1:3
ds_read2st64_b32 v[44:45], v223 offset0:0 offset1:1
ds_read2st64_b32 v[46:47], v223 offset0:2 offset1:3
Lyf_1034:
s_waitcnt lgkmcnt(0)
v_lshlrev_b32 v188, 16, v40
v_and_b32 v189, 0xffff0000, v40
v_pk_mul_f32 v[96:97], v[96:97], v[188:189]
v_lshlrev_b32 v190, 16, v41
v_and_b32 v191, 0xffff0000, v41
v_pk_mul_f32 v[98:99], v[98:99], v[190:191]
v_lshlrev_b32 v188, 16, v42
v_and_b32 v189, 0xffff0000, v42
v_pk_mul_f32 v[100:101], v[100:101], v[188:189]
v_lshlrev_b32 v190, 16, v43
v_and_b32 v191, 0xffff0000, v43
v_pk_mul_f32 v[102:103], v[102:103], v[190:191]
v_pk_fma_f32 v[112:113], v[112:113], v[96:97], v[80:81]
v_pk_fma_f32 v[114:115], v[114:115], v[98:99], v[82:83]
v_pk_fma_f32 v[116:117], v[116:117], v[100:101], v[84:85]
v_pk_fma_f32 v[118:119], v[118:119], v[102:103], v[86:87]
v_cvt_pk_bf16_f32 v120, v112, v113
v_cvt_pk_bf16_f32 v121, v114, v115
v_cvt_pk_bf16_f32 v122, v116, v117
v_cvt_pk_bf16_f32 v123, v118, v119
buffer_store_dwordx4 v[120:123], v217, s[84:87], 0 offen sc1
v_lshlrev_b32 v188, 16, v44
v_and_b32 v189, 0xffff0000, v44
v_pk_mul_f32 v[104:105], v[104:105], v[188:189]
v_lshlrev_b32 v190, 16, v45
v_and_b32 v191, 0xffff0000, v45
v_pk_mul_f32 v[106:107], v[106:107], v[190:191]
v_lshlrev_b32 v188, 16, v46
v_and_b32 v189, 0xffff0000, v46
v_pk_mul_f32 v[108:109], v[108:109], v[188:189]
v_lshlrev_b32 v190, 16, v47
v_and_b32 v191, 0xffff0000, v47
v_pk_mul_f32 v[110:111], v[110:111], v[190:191]
Ly2_1027:
v_pk_fma_f32 v[144:145], v[144:145], v[104:105], v[88:89]
v_pk_fma_f32 v[146:147], v[146:147], v[106:107], v[90:91]
v_pk_fma_f32 v[148:149], v[148:149], v[108:109], v[92:93]
v_pk_fma_f32 v[150:151], v[150:151], v[110:111], v[94:95]
v_cvt_pk_bf16_f32 v152, v144, v145
v_cvt_pk_bf16_f32 v153, v146, v147
v_cvt_pk_bf16_f32 v154, v148, v149
v_cvt_pk_bf16_f32 v155, v150, v151
buffer_store_dwordx4 v[152:155], v217, s[84:87], s89 offen sc1
s_endpgm
Lst_1003:
buffer_load_dwordx2 v[180:181], v8, s[64:67], s91 offen offset:0 sc1
buffer_load_dwordx2 v[182:183], v8, s[64:67], s91 offen offset:128 sc1
buffer_load_dwordx2 v[184:185], v8, s[64:67], s91 offen offset:256 sc1
buffer_load_dwordx2 v[186:187], v8, s[64:67], s91 offen offset:384 sc1
s_add_u32 s94, s94, 1
s_waitcnt vmcnt(0)
v_min3_u32 v10, v180, v181, v182
v_min3_u32 v11, v183, v184, v185
v_min3_u32 v10, v10, v186, v187
v_min_u32 v10, v10, v11
v_cmp_eq_u32 vcc, 0, v10
s_cmp_gt_u32 s94, 131072
s_cbranch_scc1 Lstb_1004
s_cbranch_vccnz Lst_1003
s_branch Lstb_1004
Lck_1005:
ds_read_b32 v248, v227 offset:0
s_add_u32 s94, s94, 1
s_waitcnt lgkmcnt(0)
v_cmp_ne_u32 vcc, 4, v248
s_cmp_gt_u32 s94, 1048576
s_cbranch_scc1 Lckb_1006
s_cbranch_vccnz Lck_1005
s_branch Lckb_1006
L_Mh:
s_mov_b64 s[84:85], s[26:27]
s_mov_b32 s86, 2097152
s_mov_b32 s87, 0x20000
v_lshrrev_b32 v239, 4, v0
s_mov_b32 s89, 32768
s_lshl2_add_u32 s44, s33, s32
s_lshr_b32 s45, s34, 3
s_lshl2_add_u32 s44, s44, s45
s_add_u32 s44, s44, 256
s_lshl_b32 s83, s44, 8
s_lshr_b32 s44, s38, 3
s_lshl2_add_u32 s44, s39, s44
s_lshl2_add_u32 s44, s44, s32
s_add_u32 s44, s44, 256
s_lshl_b32 s17, s44, 8
s_lshl_b32 s45, s32, 1
v_and_b32 v10, 15, v0
v_xor_b32 v10, s45, v10
v_lshlrev_b32 v10, 4, v10
v_lshl_add_u32 v220, v239, 13, v10
v_xor_b32 v221, 16, v220
s_lshl_b32 s45, s39, 18
s_lshl_b32 s46, s38, 8
s_add_u32 s45, s45, s46
s_lshl_b32 s46, s32, 16
s_add_u32 s45, s45, s46
s_add_u32 s45, s45, 3145728
s_add_u32 s46, s45, 31744
v_add_u32 v220, s45, v220
v_add_u32 v221, s46, v221
v_lshrrev_b32 v236, 3, v0
v_and_b32 v237, 7, v0
v_and_b32 v238, 1, v236
v_bfe_u32 v10, v236, 1, 1
v_lshl_add_u32 v238, v10, 2, v238
v_lshrrev_b32 v12, 2, v236
v_lshl_add_u32 v238, v12, 1, v238
s_lshl_b32 s45, s38, 6
s_lshl3_add_u32 s45, s32, s45
v_add_u32 v13, s45, v238
s_lshl_b32 s46, s39, 7
v_lshl_add_u32 v219, v237, 4, s46
v_lshl_add_u32 v217, v13, 10, v219
v_lshlrev_b32 v219, 4, v237
v_add_u32 v219, 160960, v219
v_lshlrev_b32 v218, 3, v13
v_add_u32 v218, 131072, v218
s_lshl_b32 s44, s32, 2
s_or_b32 s44, s44, 1
v_xor_b32 v10, s44, v12
v_xor_b32 v10, v10, v237
v_lshlrev_b32 v10, 4, v10
v_lshl_add_u32 v10, v237, 10, v10
v_and_b32 v12, 3, v236
v_lshl_add_u32 v10, v12, 2, v10
v_xor_b32 v223, 32, v10
v_add_u32 v222, 150912, v10
v_add_u32 v223, 150912, v223
v_and_b32 v10, 3, v238
v_lshlrev_b32 v10, 8, v10
v_lshrrev_b32 v12, 2, v238
v_lshl_add_u32 v10, v12, 6, v10
v_and_b32 v12, 1, v237
v_lshl_add_u32 v10, v12, 5, v10
s_lshl_b32 s44, s98, 7
v_add_u32 v10, s44, v10
v_bfe_u32 v12, v237, 1, 1
v_lshl_add_u32 v10, v12, 4, v10
v_lshrrev_b32 v12, 2, v237
v_lshl_add_u32 v10, v12, 7, v10
v_lshrrev_b32 v12, 1, v237
v_lshl_add_u32 v10, v12, 13, v10
s_lshl_b32 s44, s99, 10
s_mul_i32 s45, s99, 24576
v_mov_b32 v224, s44
v_mov_b32 v13, s45
v_cmp_lt_u32 vcc, 1, v237
s_nop 0
s_nop 0
v_cndmask_b32 v224, v224, v13, vcc
v_add_u32 v224, v10, v224
v_add_u32 v225, 57344, v224
v_lshrrev_b32 v11, 4, v0
s_lshl_b32 s44, s32, 8
s_add_u32 s45, s44, 159104
v_lshl_add_u32 v14, v0, 2, s45
s_xor_b32 s44, s44, 256
s_add_u32 s44, s44, 159104
v_and_b32 v15, 60, v0
v_lshl_add_u32 v15, v15, 2, s44
s_lshl_b32 s91, s35, 10
s_lshl_b32 s44, s98, 9
s_add_u32 s91, s91, s44
s_add_u32 s91, s91, 131072
s_mul_i32 s44, s99, 17600
s_lshl_b32 s45, s98, 8
s_add_u32 s44, s44, s45
s_add_u32 s45, s44, 124608
s_add_u32 s44, s44, 115784
v_and_b32 v10, 1, v0
v_bfe_u32 v12, v0, 1, 3
v_mul_u32_u24 v208, 4224, v10
v_lshl_add_u32 v208, v12, 3, v208
v_lshl_add_u32 v208, v11, 4, v208
v_add_u32 v208, s44, v208
v_mul_u32_u24 v209, 4576, v10
v_lshl_add_u32 v209, v11, 4, v209
v_add_u32 v209, s45, v209
v_lshlrev_b32 v13, 6, v12
v_sub_u32 v209, v209, v13
v_xor_b32 v211, 1, v10
v_lshlrev_b32 v211, 4, v211
v_lshlrev_b32 v213, 1, v12
v_lshl_add_u32 v213, v11, 2, v213
s_lshl_b32 s44, s32, 13
s_add_u32 s44, s44, 115712
v_add_u32 v214, s44, v1
s_add_u32 s44, s43, 115712
v_add_u32 v215, s44, v1
v_bfe_u32 v10, v0, 2, 2
v_and_b32 v13, 3, v0
v_lshlrev_b32 v10, 8, v10
v_lshl_add_u32 v10, v11, 6, v10
v_lshl_add_u32 v216, v13, 4, v10
s_lshl_b32 s44, s33, 5
s_add_u32 s44, s44, s34
s_lshl_b32 s44, s44, 13
s_add_u32 s44, s44, s43
s_add_u32 s44, s44, 3145728
v_add_u32 v216, s44, v216
s_lshl_b32 s44, s99, 7
s_add_u32 s44, s44, 160704
v_lshl_add_u32 v226, v11, 3, s44
s_lshl1_add_u32 s44, s35, s98
s_lshl1_add_u32 s46, s36, s99
s_mul_i32 s45, s44, 229376
s_lshl_b32 s47, s46, 12
s_add_u32 s45, s45, s47
s_add_u32 s80, s45, 5242880
s_add_u32 s81, s80, 114688
s_mul_i32 s45, s46, 37
s_lshr_b32 s45, s45, 8
s_lshl2_add_u32 s44, s44, s45
s_add_u32 s44, s44, 128
s_lshl_b32 s95, s44, 8
s_cmp_lg_u32 s42, 7
s_cselect_b32 s82, 1, 0
v_mov_b32 v12, 0x409d30fc
v_mov_b32 v13, 0xbeeff558
s_lshl_b32 s44, s98, 9
s_add_u32 s44, s44, 161152
v_add_u32 v9, s44, v8
s_lshl_b32 s44, s99, 4
s_lshr_b32 s16, s16, s44
s_and_b32 s16, s16, 0xffff
v_mov_b32 v10, s16
v_lshlrev_b32 v10, v211, v10
s_sub_u32 s46, s98, 1
v_and_b32 v10, s46, v10
v_cmp_eq_u32 vcc, 14, v213
v_mov_b32 v211, 0
s_nop 0
v_cndmask_b32 v210, 0, v10, vcc
v_cmp_eq_u32 vcc, 12, v213
v_mov_b32 v213, 0
s_nop 0
v_cndmask_b32 v212, 0, v10, vcc
buffer_load_dwordx4 v[240:243], v217, s[48:51], 0 offen
buffer_load_dwordx4 v[244:247], v217, s[48:51], s89 offen
s_barrier
v_mov_b32 v11, 1
s_mov_b64 exec, 1
ds_add_u32 v227, v11 offset:16
s_mov_b64 exec, -1
s_mov_b32 s94, 0
Lsy_1008:
ds_read_b32 v248, v227 offset:0
s_add_u32 s94, s94, 1
s_waitcnt lgkmcnt(0)
v_cmp_ne_u32 vcc, 4, v248
s_cmp_gt_u32 s94, 1048576
s_cbranch_scc1 Lsyd_1009
s_cbranch_vccz Lsyd_1009
s_sleep 2
s_branch Lsy_1008
Lsyd_1009:
ds_read_b128 v[128:131], v209 offset:3584
ds_read_b64 v[96:97], v208 offset:0
ds_read_b64 v[98:99], v208 offset:8
ds_read_b128 v[132:135], v209 offset:3072
ds_read_b64 v[100:101], v208 offset:512
ds_read_b64 v[102:103], v208 offset:520
ds_read_b128 v[136:139], v209 offset:2560
ds_read_b64 v[104:105], v208 offset:1024
s_branch L_Mj
Lck_1010:
ds_read_b32 v10, v227 offset:4
s_add_u32 s94, s94, 1
s_waitcnt lgkmcnt(0)
v_cmp_ne_u32 vcc, 4, v10
s_cmp_gt_u32 s94, 1048576
s_cbranch_scc1 Lckb_1011
s_cbranch_vccnz Lck_1010
s_branch Lckb_1011
Ls2_1015:
buffer_load_dwordx2 v[24:25], v218, s[64:67], 0 offen sc1
buffer_load_dwordx2 v[26:27], v218, s[64:67], 0 offen offset:256 sc1
s_add_u32 s94, s94, 1
s_waitcnt vmcnt(0)
v_min3_u32 v10, v24, v25, v26
v_min_u32 v10, v10, v27
v_cmp_eq_u32 vcc, 0, v10
s_cmp_gt_u32 s94, 131072
s_cbranch_scc1 Ls2b_1016
s_cbranch_vccnz Ls2_1015
s_branch Ls2b_1016
L_end:
s_endpgm
L_code_end:
.section .rodata,"a"
.p2align 6
.amdhsa_kernel recurrent_scan__ssm_conv_h3__dense_activation_gelu__prompt_kernel
  .amdhsa_next_free_vgpr 256
  .amdhsa_next_free_sgpr 102
  .amdhsa_accum_offset 256
  .amdhsa_group_segment_fixed_size 0
  .amdhsa_kernarg_size 112
  .amdhsa_user_sgpr_count 2
  .amdhsa_user_sgpr_kernarg_segment_ptr 1
  .amdhsa_system_sgpr_workgroup_id_x 1
  .amdhsa_float_denorm_mode_32 3
.end_amdhsa_kernel
```
